```python
import torch

def _softmax(x, axis=-1):
    return torch.softmax(x, dim=axis)
def _gelu(x):
    return torch.nn.functional.gelu(x, approximate="tanh")
def _silu(x):
    return torch.nn.functional.silu(x)
def _sigmoid(x):
    return torch.sigmoid(x)
def _layernorm(x, axis=-1, eps=1e-5):
    m = x.mean(dim=axis, keepdim=True)
    v = x.var(dim=axis, keepdim=True, unbiased=False)
    return (x - m) / torch.sqrt(v + eps)
def _scatter_add(tgt, idx, src, axis=0):
    return tgt.clone().index_add_(axis, idx, src)
def _segment_sum(src, seg, n):
    out = torch.zeros((n,) + src.shape[1:], dtype=src.dtype)
    return out.index_add_(0, seg, src)
def _pad(x, pw):
    flat = tuple(v for pair in reversed(pw) for v in pair)
    return torch.nn.functional.pad(x, flat)

kernel_name = 'standalone__adm_resblock__diffusion'

def setup_inputs():

    _w = (lambda a: (lambda t: t.to(torch.bfloat16) if t.is_floating_point() else t)(torch.as_tensor(a)))
    B, C, HW, E = 2, 512, 64, 384
    sc = (9.0 * C) ** -0.5
    return {
        "x": _w((lambda *s: torch.randn(*s, dtype=torch.bfloat16) * 0.05)(B, C, HW, HW)),
        "t_emb": _w((lambda *s: torch.randn(*s, dtype=torch.bfloat16) * 0.2)(B, E)),
        "g1": _w(1.0 + 0.1 * (lambda *s: torch.randn(*s, dtype=torch.bfloat16) * 0.2)(C)),
        "be1": _w(0.1 * (lambda *s: torch.randn(*s, dtype=torch.bfloat16) * 0.2)(C)),
        "w1": _w((lambda *s: torch.randn(*s, dtype=torch.bfloat16) * 0.2)(C, C, 3, 3) * sc),
        "w_emb": _w((lambda *s: torch.randn(*s, dtype=torch.bfloat16) * 0.2)(E, C) * (E ** -0.5)),
        "g2": _w(1.0 + 0.1 * (lambda *s: torch.randn(*s, dtype=torch.bfloat16) * 0.2)(C)),
        "be2": _w(0.1 * (lambda *s: torch.randn(*s, dtype=torch.bfloat16) * 0.2)(C)),
        "w2": _w((lambda *s: torch.randn(*s, dtype=torch.bfloat16) * 0.2)(C, C, 3, 3) * sc),
    }

def reference(x, t_emb, g1, be1, w1, w_emb, g2, be2, w2):
    B, C, H, W = x.shape
    G, eps = 4, 1e-5
    def gn(z, gamma, beta):
        zr = z.reshape(B, G, (C // G) * H * W)
        mu = zr.mean(-1).reshape(B, G, 1)
        var = ((zr - mu) ** 2).mean(-1).reshape(B, G, 1)
        zn = ((zr - mu) / torch.sqrt(var + eps)).reshape(B, C, H, W)
        return zn * gamma.reshape(1, C, 1, 1) + beta.reshape(1, C, 1, 1)
    def conv3(z, w):
        zp = _pad(z, ((0, 0), (0, 0), (1, 1), (1, 1)))
        taps = [torch.einsum("bchw,oc->bohw", zp[:, :, i:i+H, j:j+W], w[:, :, i, j]) for i in range(3) for j in range(3)]
        out = taps[0]
        for t in taps[1:]:
            out = out + t
        return out
    h = conv3(_silu(gn(x, g1, be1)), w1)
    emb = _silu(t_emb) @ w_emb
    h = h + emb.reshape(B, C, 1, 1)
    h = conv3(_silu(gn(h, g2, be2)), w2)
    return x + h
```

```asm
; @launch grid=(256,1,1) block=(256,1,1) lds=152064
.amdgcn_target "amdgcn-amd-amdhsa--gfx950"
.text
.globl standalone__adm_resblock__diffusion_kernel
.p2align 8
.type standalone__adm_resblock__diffusion_kernel,@function
standalone__adm_resblock__diffusion_kernel:
    s_cmp_ge_u32 s2, 256
    s_cbranch_scc1 Lexit
    s_load_dwordx16 s[4:19], s[0:1], 0
    s_load_dwordx8 s[20:27], s[0:1], 64
    v_lshrrev_b32 v8, 6, v0
    v_and_b32 v0, 63, v0
    v_readfirstlane_b32 s3, v8
    s_and_b32 s51, s2, 7
    s_lshr_b32 s52, s2, 3
    s_lshr_b32 s53, s51, 2
    s_and_b32 s54, s51, 3
    s_lshl_b32 s54, s54, 1
    s_and_b32 s56, s52, 1
    s_add_u32 s54, s54, s56
    s_lshr_b32 s55, s52, 1
    s_lshl_b32 s71, s51, 4
    s_add_u32 s71, s71, s55
    s_lshl_b32 s56, s52, 2
    s_add_u32 s56, s56, s3
    v_and_b32_e64 v8, 1, v0
    v_lshl_add_u32 v8, v8, 7, s56
    s_getpc_b64 s[56:57]
Lpc:
    s_add_u32 s56, s56, Lpf-Lpc
    s_addc_u32 s57, s57, 0
    v_lshlrev_b32_e64 v72, 7, v8
    v_min_u32 v72, Lcode_end-Lpf-4, v72
    v_mov_b32 v73, s57
    v_add_co_u32 v72, vcc, s56, v72
    s_nop 1
    v_addc_co_u32 v73, vcc, 0, v73, vcc
    global_load_dword v253, v[72:73], off
Lpf:
    v_and_b32 v9, 15, v0
    v_lshrrev_b32 v10, 4, v0
    v_lshlrev_b32 v1, 4, v0
    s_and_b32 s44, s3, 1
    s_lshl_b32 s56, s54, 1
    s_add_u32 s44, s44, s56
    s_lshr_b32 s45, s3, 1
    s_lshl_b32 s56, s55, 1
    s_add_u32 s45, s45, s56
    s_lshl_b32 s46, s53, 22
    s_lshl_b32 s56, s44, 18
    s_add_u32 s46, s46, s56
    s_lshl_b32 s47, s45, 8
    s_add_u32 s47, s47, s46
    v_lshlrev_b32_e64 v11, 16, v10
    v_lshl_add_u32 v11, v9, 3, v11
    s_cmp_eq_u32 s3, 3
    s_cselect_b32 s56, 128, 0
    v_add_u32 v247, s56, v11
    v_xor_b32 v248, 128, v247
    s_mov_b32 s70, 0xffff0000
    s_waitcnt lgkmcnt(0)
    s_load_dword s62, s[26:27], 0
    s_mov_b32 s36, s4
    s_mov_b32 s37, s5
    s_mov_b32 s38, 0x800000
    s_mov_b32 s39, 0x20000
    s_mov_b32 s59, s47
    buffer_load_dwordx2 v[200:201], v247, s[36:39], s59 offen nt
    buffer_load_dwordx2 v[216:217], v248, s[36:39], s59 offen nt
    s_add_u32 s59, s59, 8192
    buffer_load_dwordx2 v[202:203], v247, s[36:39], s59 offen nt
    buffer_load_dwordx2 v[218:219], v248, s[36:39], s59 offen nt
    s_add_u32 s59, s59, 8192
    buffer_load_dwordx2 v[204:205], v247, s[36:39], s59 offen nt
    buffer_load_dwordx2 v[220:221], v248, s[36:39], s59 offen nt
    s_add_u32 s59, s59, 8192
    buffer_load_dwordx2 v[206:207], v247, s[36:39], s59 offen nt
    buffer_load_dwordx2 v[222:223], v248, s[36:39], s59 offen nt
    s_add_u32 s59, s59, 8192
    buffer_load_dwordx2 v[208:209], v247, s[36:39], s59 offen nt
    buffer_load_dwordx2 v[224:225], v248, s[36:39], s59 offen nt
    s_add_u32 s59, s59, 8192
    buffer_load_dwordx2 v[210:211], v247, s[36:39], s59 offen nt
    buffer_load_dwordx2 v[226:227], v248, s[36:39], s59 offen nt
    s_add_u32 s59, s59, 8192
    buffer_load_dwordx2 v[212:213], v247, s[36:39], s59 offen nt
    buffer_load_dwordx2 v[228:229], v248, s[36:39], s59 offen nt
    s_add_u32 s59, s59, 8192
    buffer_load_dwordx2 v[214:215], v247, s[36:39], s59 offen nt
    buffer_load_dwordx2 v[230:231], v248, s[36:39], s59 offen nt
    s_mov_b32 s40, s12
    s_mov_b32 s41, s13
    s_mov_b32 s42, 0x480000
    s_mov_b32 s43, 0x20000
    s_cmp_lt_u32 s3, 2
    s_cbranch_scc1 Lside0
    s_cmp_eq_u32 s3, 3
    s_cbranch_scc1 Lside3
    global_load_dwordx4 v[16:19], v1, s[8:9]
    global_load_dwordx4 v[20:23], v1, s[10:11]
    global_load_dwordx4 v[24:27], v1, s[16:17]
    global_load_dwordx4 v[28:31], v1, s[18:19]
    s_branch Lside0
Lside3:
    v_lshrrev_b32 v12, 3, v0
    s_mul_i32 s56, s55, 24
    v_add_u32_e64 v12, s56, v12
    s_and_b32 s56, s52, 1
    s_mul_i32 s56, s56, 768
    v_lshl_add_u32 v13, v12, 1, s56
    global_load_ushort v16, v13, s[6:7] offset:0
    global_load_ushort v17, v13, s[6:7] offset:16
    global_load_ushort v18, v13, s[6:7] offset:32
    v_and_b32 v13, 7, v0
    v_lshlrev_b32 v13, 4, v13
    v_lshl_add_u32 v13, v12, 10, v13
    s_lshl_b32 s56, s51, 7
    v_add_u32 v13, s56, v13
    global_load_dwordx4 v[20:23], v13, s[14:15]
    v_add_u32 v13, 8192, v13
    global_load_dwordx4 v[24:27], v13, s[14:15]
    v_add_u32 v13, 8192, v13
    global_load_dwordx4 v[28:31], v13, s[14:15]
Lside0:
    s_mov_b32 s13, s47
    s_mov_b32 s28, s26
    s_mov_b32 s29, s27
    s_mov_b32 s30, 0x10000000
    s_mov_b32 s31, 0x20000
    s_mul_i32 s12, s51, 4352
    s_lshl_b32 s56, s52, 7
    s_add_u32 s12, s12, s56
    s_cmp_eq_u32 s3, 0
    s_cselect_b32 s58, 5, 0
    v_lshrrev_b32 v11, 3, v0
    v_min_u32 v11, s58, v11
    v_lshlrev_b32 v11, 16, v11
    v_and_b32 v14, 0x70, v1
    v_add_u32 v11, v11, v14
    v_mov_b32 v132, 0
    v_mov_b32 v133, -1
    v_mov_b32 v134, 0
    v_mov_b32 v135, 0
    s_mov_b32 s57, 0x40000000
    s_add_u32 s56, s12, 0x40000
    s_cmp_eq_u32 s3, 0
    s_cselect_b32 s57, s56, s57
    buffer_store_dwordx4 v[132:135], v11, s[28:31], s57 offen sc1
    v_mul_u32_u24 v246, 65792, v10
    v_lshl_add_u32 v246, v9, 4, v246
    s_mul_i32 s46, s53, 4210688
    s_add_u32 s56, s46, 0xffc00
    s_mul_i32 s57, s44, 263168
    s_add_u32 s46, s46, s57
    s_add_u32 s32, s26, s56
    s_addc_u32 s33, s27, 0
    s_mov_b32 s34, 0x404400
    s_mov_b32 s35, 0x20000
    s_lshl_b32 s56, s45, 11
    s_add_u32 s66, s46, s56
    s_add_u32 s66, s66, 0x100000
    s_cmp_eq_u32 s3, 3
    s_cselect_b32 s56, 1024, 0
    s_cselect_b32 s57, 0, 1024
    s_add_u32 s67, s66, s57
    s_add_u32 s66, s66, s56
    s_lshl_b32 s56, s44, 6
    v_lshlrev_b32 v237, 4, v10
    v_add_u32_e64 v237, s56, v237
    v_add_u32 v2, 4096, v1
    s_cmp_eq_u32 s55, 0
    s_cselect_b32 s56, 0x40000000, 0
    v_add_u32 v3, s56, v1
    s_cmp_eq_u32 s55, 15
    s_cselect_b32 s56, 0x40000000, 0
    v_add_u32 v4, s56, v2
    v_lshrrev_b32 v11, 2, v9
    v_lshlrev_b32 v11, 8, v11
    v_lshl_add_u32 v11, v10, 6, v11
    v_and_b32_e64 v14, 3, v9
    v_lshl_add_u32 v5, v14, 4, v11
    s_lshl_b32 s57, s3, 10
    s_lshr_b32 s56, s3, 1
    s_sub_u32 s58, 2, s56
    s_lshl_b32 s58, s58, 10
    s_lshl_b32 s56, s56, 11
    v_mul_u32_u24 v11, 6144, v10
    v_lshl_add_u32 v11, v9, 4, v11
    v_add_u32 v14, s56, v11
    s_xor_b32 s56, s56, 2048
    v_add_u32 v11, s56, v11
    v_add_u32 v6, s57, v14
    v_add_u32 v7, s58, v14
    v_add_u32 v254, s57, v11
    v_add_u32_e64 v255, s58, v11
    s_mov_b32 s56, 0xbc00bc00
    s_cmp_eq_u32 s3, 1
    s_cselect_b32 s49, 0x3c003c00, s56
    s_mul_i32 s45, s3, 6144
    s_xor_b32 s56, s3, 1
    s_mul_i32 s56, s56, 3
    s_add_u32 s56, s56, 0
    s_lshl_b32 s56, s56, 13
    v_add_u32 v240, s56, v1
    s_xor_b32 s56, s3, 2
    s_mul_i32 s56, s56, 3
    s_add_u32 s56, s56, 1
    s_lshl_b32 s56, s56, 13
    v_add_u32 v241, s56, v1
    s_xor_b32 s56, s3, 3
    s_mul_i32 s56, s56, 3
    s_add_u32 s56, s56, 2
    s_lshl_b32 s56, s56, 13
    v_add_u32 v242, s56, v1
    s_lshl_b32 s57, s3, 2
    s_mul_i32 s58, s3, 3
    s_lshr_b32 s56, 0x1100, s57
    s_and_b32 s56, s56, 15
    s_add_u32 s56, s56, s58
    s_lshl_b32 s56, s56, 13
    v_add_u32 v243, s56, v1
    s_lshr_b32 s56, 0x221, s57
    s_and_b32 s56, s56, 15
    s_add_u32 s56, s56, s58
    s_lshl_b32 s56, s56, 13
    v_add_u32 v244, s56, v1
    s_lshr_b32 s56, 0x2012, s57
    s_and_b32 s56, s56, 15
    s_add_u32 s56, s56, s58
    s_lshl_b32 s56, s56, 13
    v_add_u32 v245, s56, v1
    s_cmp_eq_u32 s3, 3
    s_cselect_b32 s6, -1.0, 1.0
    s_cmp_ge_u32 s3, 2
    s_cselect_b32 s7, 1.0, -1.0
    s_xor_b32 s15, s7, 0x80000000
    s_add_u32 s56, s3, 1
    s_bitcmp1_b32 s56, 1
    s_cselect_b32 s14, 0, 1.0
    s_cselect_b32 s15, s15, 0
    s_cselect_b64 s[4:5], -1, 0
    v_cmp_eq_u32 vcc, 63, v0
    v_mov_b32_e64 v11, 0x40000000
    v_mov_b32 v250, 151808
    v_cndmask_b32 v249, v11, 0, vcc
    s_mov_b32 s60, 0
    v_and_b32 v35, 7, v0
    v_lshlrev_b32_e64 v35, 5, v35
    v_lshl_add_u32 v35, v10, 3, v35
    s_and_b32 s56, s52, 1
    s_lshl_b32 s56, s56, 7
    s_add_u32 s56, s56, s71
    s_lshl_b32 s56, s56, 8
    s_add_u32 s65, s56, 0x10000
    v_and_b32 v11, 3, v0
    v_lshrrev_b32 v14, 2, v0
    v_mul_u32_u24 v11, 9280, v11
    v_mul_u32_u24 v14, 144, v14
    s_mul_i32 s58, s3, 2304
    s_add_u32 s58, s58, 114688
    v_add3_u32 v238, v11, v14, s58
    v_mul_u32_u24 v236, 49152, v10
    v_lshl_add_u32 v236, v9, 4, v236
    s_mul_i32 s56, s51, 790528
    s_add_u32 s56, s56, 0x1110000
    s_bfe_u32 s58, s55, 0x10003
    s_lshl_b32 s58, s58, 11
    s_add_u32 s56, s56, s58
    s_and_b32 s58, s55, 1
    s_lshl_b32 s58, s58, 10
    s_add_u32 s56, s56, s58
    s_bfe_u32 s58, s55, 0x20001
    s_lshl_b32 s58, s58, 8
    s_add_u32 s56, s56, s58
    s_mul_i32 s58, s3, 196608
    s_add_u32 s56, s56, s58
    s_xor_b32 s58, s56, 2048
    s_bitcmp1_b32 s52, 0
    s_cselect_b32 s68, s58, s56
    s_cselect_b32 s69, s56, s58
    s_cselect_b32 s58, 36864, 0
    s_cselect_b32 s59, 12288, 0
    s_add_u32 s68, s68, s58
    s_add_u32 s69, s69, s59
    s_add_u32 s69, s69, 12288
    s_waitcnt vmcnt(13)
    v_lshlrev_b32 v136, 16, v200
    v_and_b32 v144, s70, v200
    v_lshlrev_b32 v152, 16, v201
    v_and_b32 v160, s70, v201
    v_lshlrev_b32 v168, 16, v216
    v_and_b32 v176, s70, v216
    v_lshlrev_b32 v184, 16, v217
    v_and_b32 v192, s70, v217
    v_lshlrev_b32 v137, 16, v202
    v_and_b32 v145, s70, v202
    v_lshlrev_b32 v153, 16, v203
    v_and_b32 v161, s70, v203
    v_lshlrev_b32 v169, 16, v218
    v_and_b32 v177, s70, v218
    v_lshlrev_b32 v185, 16, v219
    v_and_b32 v193, s70, v219
    v_pk_mul_f32 v[120:121], v[136:137], v[136:137]
    v_pk_mul_f32 v[116:117], v[136:137], 1.0 op_sel_hi:[1,0]
    v_pk_mul_f32 v[122:123], v[144:145], v[144:145]
    v_pk_mul_f32 v[118:119], v[144:145], 1.0 op_sel_hi:[1,0]
    v_pk_add_f32 v[116:117], v[116:117], v[152:153]
    v_pk_fma_f32 v[120:121], v[152:153], v[152:153], v[120:121]
    v_pk_add_f32 v[118:119], v[118:119], v[160:161]
    v_pk_fma_f32 v[122:123], v[160:161], v[160:161], v[122:123]
    v_pk_add_f32 v[116:117], v[116:117], v[168:169]
    v_pk_fma_f32 v[120:121], v[168:169], v[168:169], v[120:121]
    v_pk_add_f32 v[118:119], v[118:119], v[176:177]
    v_pk_fma_f32 v[122:123], v[176:177], v[176:177], v[122:123]
    v_pk_add_f32 v[116:117], v[116:117], v[184:185]
    v_pk_fma_f32 v[120:121], v[184:185], v[184:185], v[120:121]
    v_pk_add_f32 v[118:119], v[118:119], v[192:193]
    v_pk_fma_f32 v[122:123], v[192:193], v[192:193], v[122:123]
    s_mul_i32 s46, s3, 9280
    s_add_u32 m0, s46, 114688
    s_lshl_b32 s44, s71, 2
    s_add_u32 s44, s44, s3
    s_mul_i32 s44, s44, 9216
    buffer_load_dwordx4 v1, s[40:43], s44 offen offset:0 nt lds
    buffer_load_dwordx4 v1, s[40:43], s44 offen offset:1024 nt lds
    buffer_load_dwordx4 v1, s[40:43], s44 offen offset:2048 nt lds
    s_waitcnt vmcnt(12)
    v_lshlrev_b32 v138, 16, v204
    v_and_b32 v146, s70, v204
    v_lshlrev_b32 v154, 16, v205
    v_and_b32 v162, s70, v205
    v_lshlrev_b32 v170, 16, v220
    v_and_b32 v178, s70, v220
    v_lshlrev_b32 v186, 16, v221
    v_and_b32 v194, s70, v221
    v_lshlrev_b32 v139, 16, v206
    v_and_b32 v147, s70, v206
    v_lshlrev_b32 v155, 16, v207
    v_and_b32 v163, s70, v207
    v_lshlrev_b32 v171, 16, v222
    v_and_b32 v179, s70, v222
    v_lshlrev_b32 v187, 16, v223
    v_and_b32_e64 v195, s70, v223
    v_pk_add_f32 v[116:117], v[116:117], v[138:139]
    v_pk_fma_f32 v[120:121], v[138:139], v[138:139], v[120:121]
    v_pk_add_f32 v[118:119], v[118:119], v[146:147]
    v_pk_fma_f32 v[122:123], v[146:147], v[146:147], v[122:123]
    v_pk_add_f32 v[116:117], v[116:117], v[154:155]
    v_pk_fma_f32 v[120:121], v[154:155], v[154:155], v[120:121]
    v_pk_add_f32 v[118:119], v[118:119], v[162:163]
    v_pk_fma_f32 v[122:123], v[162:163], v[162:163], v[122:123]
    v_pk_add_f32 v[116:117], v[116:117], v[170:171]
    v_pk_fma_f32 v[120:121], v[170:171], v[170:171], v[120:121]
    v_pk_add_f32 v[118:119], v[118:119], v[178:179]
    v_pk_fma_f32 v[122:123], v[178:179], v[178:179], v[122:123]
    v_pk_add_f32 v[116:117], v[116:117], v[186:187]
    v_pk_fma_f32 v[120:121], v[186:187], v[186:187], v[120:121]
    v_pk_add_f32 v[118:119], v[118:119], v[194:195]
    v_pk_fma_f32 v[122:123], v[194:195], v[194:195], v[122:123]
    buffer_load_dwordx4 v1, s[40:43], s44 offen offset:3072 nt lds
    s_add_u32 m0, s46, 118784
    s_add_u32 s44, s44, 4096
    buffer_load_dwordx4 v1, s[40:43], s44 offen offset:0 nt lds
    buffer_load_dwordx4 v1, s[40:43], s44 offen offset:1024 nt lds
    s_waitcnt vmcnt(11)
    v_lshlrev_b32 v140, 16, v208
    v_and_b32 v148, s70, v208
    v_lshlrev_b32 v156, 16, v209
    v_and_b32 v164, s70, v209
    v_lshlrev_b32 v172, 16, v224
    v_and_b32 v180, s70, v224
    v_lshlrev_b32 v188, 16, v225
    v_and_b32 v196, s70, v225
    v_lshlrev_b32 v141, 16, v210
    v_and_b32 v149, s70, v210
    v_lshlrev_b32 v157, 16, v211
    v_and_b32 v165, s70, v211
    v_lshlrev_b32 v173, 16, v226
    v_and_b32 v181, s70, v226
    v_lshlrev_b32 v189, 16, v227
    v_and_b32_e64 v197, s70, v227
    v_pk_add_f32 v[116:117], v[116:117], v[140:141]
    v_pk_fma_f32 v[120:121], v[140:141], v[140:141], v[120:121]
    v_pk_add_f32 v[118:119], v[118:119], v[148:149]
    v_pk_fma_f32 v[122:123], v[148:149], v[148:149], v[122:123]
    v_pk_add_f32 v[116:117], v[116:117], v[156:157]
    v_pk_fma_f32 v[120:121], v[156:157], v[156:157], v[120:121]
    v_pk_add_f32 v[118:119], v[118:119], v[164:165]
    v_pk_fma_f32 v[122:123], v[164:165], v[164:165], v[122:123]
    v_pk_add_f32 v[116:117], v[116:117], v[172:173]
    v_pk_fma_f32 v[120:121], v[172:173], v[172:173], v[120:121]
    v_pk_add_f32 v[118:119], v[118:119], v[180:181]
    v_pk_fma_f32 v[122:123], v[180:181], v[180:181], v[122:123]
    v_pk_add_f32 v[116:117], v[116:117], v[188:189]
    v_pk_fma_f32 v[120:121], v[188:189], v[188:189], v[120:121]
    v_pk_add_f32 v[118:119], v[118:119], v[196:197]
    v_pk_fma_f32 v[122:123], v[196:197], v[196:197], v[122:123]
    buffer_load_dwordx4 v1, s[40:43], s44 offen offset:2048 nt lds
    buffer_load_dwordx4 v1, s[40:43], s44 offen offset:3072 nt lds
    s_add_u32 m0, s46, 122880
    s_add_u32 s44, s44, 4096
    buffer_load_dwordx4 v1, s[40:43], s44 offen offset:0 nt lds
    s_waitcnt vmcnt(9)
    v_lshlrev_b32 v142, 16, v212
    v_and_b32 v150, s70, v212
    v_lshlrev_b32 v158, 16, v213
    v_and_b32 v166, s70, v213
    v_lshlrev_b32 v174, 16, v228
    v_and_b32 v182, s70, v228
    v_lshlrev_b32 v190, 16, v229
    v_and_b32 v198, s70, v229
    v_lshlrev_b32 v143, 16, v214
    v_and_b32 v151, s70, v214
    v_lshlrev_b32 v159, 16, v215
    v_and_b32 v167, s70, v215
    v_lshlrev_b32 v175, 16, v230
    v_and_b32 v183, s70, v230
    v_lshlrev_b32 v191, 16, v231
    v_and_b32_e64 v199, s70, v231
    v_pk_add_f32 v[116:117], v[116:117], v[142:143]
    v_pk_fma_f32 v[120:121], v[142:143], v[142:143], v[120:121]
    v_pk_add_f32 v[118:119], v[118:119], v[150:151]
    v_pk_fma_f32 v[122:123], v[150:151], v[150:151], v[122:123]
    v_pk_add_f32 v[116:117], v[116:117], v[158:159]
    v_pk_fma_f32 v[120:121], v[158:159], v[158:159], v[120:121]
    v_pk_add_f32 v[118:119], v[118:119], v[166:167]
    v_pk_fma_f32 v[122:123], v[166:167], v[166:167], v[122:123]
    v_pk_add_f32 v[116:117], v[116:117], v[174:175]
    v_pk_fma_f32 v[120:121], v[174:175], v[174:175], v[120:121]
    v_pk_add_f32 v[118:119], v[118:119], v[182:183]
    v_pk_fma_f32 v[122:123], v[182:183], v[182:183], v[122:123]
    v_pk_add_f32 v[116:117], v[116:117], v[190:191]
    v_pk_fma_f32 v[120:121], v[190:191], v[190:191], v[120:121]
    v_pk_add_f32 v[118:119], v[118:119], v[198:199]
    v_pk_fma_f32 v[122:123], v[198:199], v[198:199], v[122:123]
Lstats:
    v_pk_add_f32 v[116:117], v[116:117], v[118:119]
    v_pk_add_f32 v[120:121], v[120:121], v[122:123]
    v_add_f32 v116, v116, v117
    v_add_f32_e64 v117, v120, v121
    s_nop 0
    v_add_f32_dpp v116, v116, v116 row_shr:1 row_mask:0xf bank_mask:0xf bound_ctrl:1
    v_add_f32_dpp v117, v117, v117 row_shr:1 row_mask:0xf bank_mask:0xf bound_ctrl:1
    s_nop 0
    v_add_f32_dpp v116, v116, v116 row_shr:2 row_mask:0xf bank_mask:0xf bound_ctrl:1
    v_add_f32_dpp v117, v117, v117 row_shr:2 row_mask:0xf bank_mask:0xf bound_ctrl:1
    s_nop 0
    v_add_f32_dpp v116, v116, v116 row_shr:4 row_mask:0xf bank_mask:0xf bound_ctrl:1
    v_add_f32_dpp v117, v117, v117 row_shr:4 row_mask:0xf bank_mask:0xf bound_ctrl:1
    s_nop 0
    v_add_f32_dpp v116, v116, v116 row_shr:8 row_mask:0xf bank_mask:0xf bound_ctrl:1
    v_add_f32_dpp v117, v117, v117 row_shr:8 row_mask:0xf bank_mask:0xf bound_ctrl:1
    s_nop 0
    v_add_f32_dpp v116, v116, v116 row_bcast:15 row_mask:0xa bank_mask:0xf
    v_add_f32_dpp v117, v117, v117 row_bcast:15 row_mask:0xa bank_mask:0xf
    s_nop 0
    v_add_f32_dpp v116, v116, v116 row_bcast:31 row_mask:0xc bank_mask:0xf
    v_add_f32_dpp v117, v117, v117 row_bcast:31 row_mask:0xc bank_mask:0xf
    s_lshl_b32 s56, s3, 3
    v_add_u32 v118, s56, v250
    s_mov_b32 exec_lo, 0
    s_mov_b32 exec_hi, 0x80000000
    ds_write_b64 v118, v[116:117]
    s_mov_b64 exec, -1
    s_lshl_b32 s59, s60, 16
    s_add_u32 s56, s59, s12
    s_add_u32 s56, s56, 0x40000
    s_cmp_eq_u32 s60, 0
    s_cbranch_scc1 Lb1
    s_waitcnt vmcnt(0)
Lb1:
    s_waitcnt lgkmcnt(0)
    s_barrier
    s_add_u32 s61, s62, 0x9e3779b9
    s_cmp_lg_u32 s3, 0
    s_cbranch_scc1 Lnopub
    ds_read_b128 v[116:119], v250
    ds_read_b128 v[120:123], v250 offset:16
    v_mov_b32 v133, s61
    v_mov_b32_e64 v135, s61
    s_waitcnt lgkmcnt(0)
    v_pk_add_f32 v[116:117], v[116:117], v[118:119]
    v_pk_add_f32 v[120:121], v[120:121], v[122:123]
    v_add_f32 v132, v116, v120
    v_add_f32 v134, v117, v121
    v_and_b32 v116, 0x70, v1
    buffer_store_dwordx4 v[132:135], v116, s[28:31], s56 offen sc1
Lnopub:
    s_mul_i32 s25, s51, 4352
    s_add_u32 s25, s25, s59
    s_add_u32 s25, s25, 0x40000
    v_cmp_gt_u32 vcc, 32, v0
    v_mov_b32 v116, 0x40000000
    v_lshlrev_b32 v251, 7, v0
    v_cndmask_b32_e64 v251, v116, v251, vcc
    s_cmp_lg_u32 s60, 0
    s_cbranch_scc1 Ljob
    s_mov_b32 s40, s20
    s_mov_b32 s41, s21
    global_load_dwordx4 v[124:127], v237, s[8:9]
    global_load_dwordx4 v[128:131], v237, s[10:11]
    s_cmp_lt_u32 s3, 2
    s_cbranch_scc1 Lside1
    s_nop 0
    s_cmp_eq_u32 s3, 3
    s_cbranch_scc1 Lside4
    v_mov_b32 v12, 0
    v_mov_b32 v13, 0
    v_lshlrev_b32 v14, 16, v16
    v_and_b32_e64 v15, s70, v16
    v_max3_f32 v12, |v14|, |v15|, v12
    v_lshlrev_b32 v14, 16, v17
    v_and_b32 v15, s70, v17
    v_max3_f32 v12, |v14|, |v15|, v12
    v_lshlrev_b32 v14, 16, v18
    v_and_b32 v15, s70, v18
    v_max3_f32 v12, |v14|, |v15|, v12
    v_lshlrev_b32 v14, 16, v19
    v_and_b32 v15, s70, v19
    v_max3_f32 v12, |v14|, |v15|, v12
    v_lshlrev_b32 v14, 16, v20
    v_and_b32 v15, s70, v20
    v_max3_f32 v12, |v14|, |v15|, v12
    v_lshlrev_b32 v14, 16, v21
    v_and_b32 v15, s70, v21
    v_max3_f32 v12, |v14|, |v15|, v12
    v_lshlrev_b32 v14, 16, v22
    v_and_b32 v15, s70, v22
    v_max3_f32 v12, |v14|, |v15|, v12
    v_lshlrev_b32 v14, 16, v23
    v_and_b32 v15, s70, v23
    v_max3_f32 v12, |v14|, |v15|, v12
    v_lshlrev_b32 v14, 16, v24
    v_and_b32 v15, s70, v24
    v_max3_f32 v13, |v14|, |v15|, v13
    v_lshlrev_b32 v14, 16, v25
    v_and_b32 v15, s70, v25
    v_max3_f32 v13, |v14|, |v15|, v13
    v_lshlrev_b32 v14, 16, v26
    v_and_b32 v15, s70, v26
    v_max3_f32 v13, |v14|, |v15|, v13
    v_lshlrev_b32 v14, 16, v27
    v_and_b32 v15, s70, v27
    v_max3_f32 v13, |v14|, |v15|, v13
    v_lshlrev_b32 v14, 16, v28
    v_and_b32 v15, s70, v28
    v_max3_f32 v13, |v14|, |v15|, v13
    v_lshlrev_b32 v14, 16, v29
    v_and_b32 v15, s70, v29
    v_max3_f32 v13, |v14|, |v15|, v13
    v_lshlrev_b32 v14, 16, v30
    v_and_b32 v15, s70, v30
    v_max3_f32 v13, |v14|, |v15|, v13
    v_lshlrev_b32 v14, 16, v31
    v_and_b32 v15, s70, v31
    v_max3_f32 v13, |v14|, |v15|, v13
    s_nop 0
    s_nop 0
    v_max_f32_dpp v12, v12, v12 row_shr:1 row_mask:0xf bank_mask:0xf bound_ctrl:1
    v_max_f32_dpp v13, v13, v13 row_shr:1 row_mask:0xf bank_mask:0xf bound_ctrl:1
    s_nop 0
    v_max_f32_dpp v12, v12, v12 row_shr:2 row_mask:0xf bank_mask:0xf bound_ctrl:1
    v_max_f32_dpp v13, v13, v13 row_shr:2 row_mask:0xf bank_mask:0xf bound_ctrl:1
    s_nop 0
    v_max_f32_dpp v12, v12, v12 row_shr:4 row_mask:0xf bank_mask:0xf bound_ctrl:1
    v_max_f32_dpp v13, v13, v13 row_shr:4 row_mask:0xf bank_mask:0xf bound_ctrl:1
    s_nop 0
    v_max_f32_dpp v12, v12, v12 row_shr:8 row_mask:0xf bank_mask:0xf bound_ctrl:1
    v_max_f32_dpp v13, v13, v13 row_shr:8 row_mask:0xf bank_mask:0xf bound_ctrl:1
    s_nop 0
    v_max_f32_dpp v12, v12, v12 row_bcast:15 row_mask:0xa bank_mask:0xf
    v_max_f32_dpp v13, v13, v13 row_bcast:15 row_mask:0xa bank_mask:0xf
    s_nop 0
    v_max_f32_dpp v12, v12, v12 row_bcast:31 row_mask:0xc bank_mask:0xf
    v_max_f32_dpp v13, v13, v13 row_bcast:31 row_mask:0xc bank_mask:0xf
    v_frexp_exp_i32_f32 v12, v12
    v_min_i32_e64 v12, 60, v12
    v_max_i32 v12, 0xffffffc4, v12
    v_frexp_exp_i32_f32 v13, v13
    v_min_i32 v13, 60, v13
    v_max_i32 v13, 0xffffffc4, v13
    s_mov_b32 exec_lo, 0
    s_mov_b32 exec_hi, 0x80000000
    ds_write_b64 v250, v[12:13] offset:72
    s_mov_b64 exec, -1
    s_branch Lside1
Lside4:
    v_lshlrev_b32 v16, 16, v16
    v_lshlrev_b32 v17, 16, v17
    v_lshlrev_b32 v18, 16, v18
    v_mul_f32 v32, 0xbfb8aa3b, v16
    v_mul_f32 v33, 0xbfb8aa3b, v17
    v_mul_f32 v34, 0xbfb8aa3b, v18
    v_exp_f32 v32, v32
    v_exp_f32 v33, v33
    v_exp_f32 v34, v34
    v_add_f32 v32, 1.0, v32
    v_add_f32 v33, 1.0, v33
    v_add_f32 v34, 1.0, v34
    v_rcp_f32 v32, v32
    v_rcp_f32 v33, v33
    v_rcp_f32 v34, v34
    v_mul_f32 v16, v16, v32
    v_mul_f32 v17, v17, v33
    v_mul_f32 v18, v18, v34
    v_lshlrev_b32 v44, 16, v20
    v_and_b32 v45, s70, v20
    v_lshlrev_b32 v46, 16, v21
    v_and_b32 v47, s70, v21
    v_lshlrev_b32 v48, 16, v22
    v_and_b32 v49, s70, v22
    v_lshlrev_b32 v50, 16, v23
    v_and_b32 v51, s70, v23
    v_mul_f32 v36, v44, v16
    v_mul_f32 v37, v45, v16
    v_mul_f32 v38, v46, v16
    v_mul_f32 v39, v47, v16
    v_mul_f32 v40, v48, v16
    v_mul_f32 v41, v49, v16
    v_mul_f32 v42, v50, v16
    v_mul_f32 v43, v51, v16
    v_lshlrev_b32 v44, 16, v24
    v_and_b32 v45, s70, v24
    v_lshlrev_b32 v46, 16, v25
    v_and_b32 v47, s70, v25
    v_lshlrev_b32 v48, 16, v26
    v_and_b32 v49, s70, v26
    v_lshlrev_b32 v50, 16, v27
    v_and_b32 v51, s70, v27
    v_fmac_f32 v36, v44, v17
    v_fmac_f32 v37, v45, v17
    v_fmac_f32 v38, v46, v17
    v_fmac_f32 v39, v47, v17
    v_fmac_f32 v40, v48, v17
    v_fmac_f32 v41, v49, v17
    v_fmac_f32 v42, v50, v17
    v_fmac_f32 v43, v51, v17
    v_lshlrev_b32 v44, 16, v28
    v_and_b32 v45, s70, v28
    v_lshlrev_b32 v46, 16, v29
    v_and_b32 v47, s70, v29
    v_lshlrev_b32 v48, 16, v30
    v_and_b32 v49, s70, v30
    v_lshlrev_b32 v50, 16, v31
    v_and_b32 v51, s70, v31
    v_fmac_f32 v36, v44, v18
    v_fmac_f32 v37, v45, v18
    v_fmac_f32 v38, v46, v18
    v_fmac_f32 v39, v47, v18
    v_fmac_f32 v40, v48, v18
    v_fmac_f32 v41, v49, v18
    v_fmac_f32 v42, v50, v18
    v_fmac_f32 v43, v51, v18
    v_add_f32_dpp v36, v36, v36 row_ror:8 row_mask:0xf bank_mask:0xf
    v_add_f32_dpp v37, v37, v37 row_ror:8 row_mask:0xf bank_mask:0xf
    v_add_f32_dpp v38, v38, v38 row_ror:8 row_mask:0xf bank_mask:0xf
    v_add_f32_dpp v39, v39, v39 row_ror:8 row_mask:0xf bank_mask:0xf
    v_add_f32_dpp v40, v40, v40 row_ror:8 row_mask:0xf bank_mask:0xf
    v_add_f32_dpp v41, v41, v41 row_ror:8 row_mask:0xf bank_mask:0xf
    v_add_f32_dpp v42, v42, v42 row_ror:8 row_mask:0xf bank_mask:0xf
    v_add_f32_dpp v43, v43, v43 row_ror:8 row_mask:0xf bank_mask:0xf
    s_nop 1
    v_permlane16_swap_b32 v36, v38
    v_permlane16_swap_b32 v37, v39
    v_permlane16_swap_b32 v40, v42
    v_permlane16_swap_b32 v41, v43
    v_add_f32 v36, v36, v38
    v_add_f32 v37, v37, v39
    v_add_f32 v40, v40, v42
    v_add_f32 v41, v41, v43
    s_nop 1
    v_permlane32_swap_b32 v36, v40
    v_permlane32_swap_b32 v37, v41
    v_add_f32 v36, v36, v40
    v_add_f32 v37, v37, v41
Lside1:
    s_cmp_eq_u32 s3, 3
    s_cselect_b32 s56, s65, 0x40000000
    buffer_store_dwordx2 v[36:37], v35, s[28:31], s56 offen sc1
    s_cmp_eq_u32 s3, 0
    s_cbranch_scc1 Lw3
    s_waitcnt vmcnt(3)
Lw3:
    s_waitcnt vmcnt(4)
    s_barrier
Ljob:
    s_nop 0
    ds_read_b128 v[80:83], v238 offset:0
    ds_read_b128 v[84:87], v238 offset:16
    ds_read_b128 v[88:91], v238 offset:32
    ds_read_b128 v[92:95], v238 offset:48
    ds_read_b128 v[96:99], v238 offset:64
    ds_read_b128 v[100:103], v238 offset:80
    ds_read_b128 v[104:107], v238 offset:96
    ds_read_b128 v[108:111], v238 offset:112
    ds_read_b128 v[112:115], v238 offset:128
    s_bitcmp1_b32 s52, 0
    s_cselect_b32 s56, -1.0, 1.0
    s_lshl_b32 s58, s3, 2
    v_add_u32 v117, s58, v250
    s_waitcnt lgkmcnt(8)
    v_lshlrev_b32 v8, 16, v80
    v_and_b32 v16, s70, v80
    v_lshlrev_b32 v24, 16, v81
    v_and_b32 v32, s70, v81
    v_lshlrev_b32 v40, 16, v82
    v_and_b32 v48, s70, v82
    v_lshlrev_b32 v56, 16, v83
    v_and_b32_e64 v64, s70, v83
    v_max3_f32 v116, |v8|, |v16|, 0
    v_max3_f32 v116, |v24|, |v32|, v116
    v_max3_f32 v116, |v40|, |v48|, v116
    v_max3_f32 v116, |v56|, |v64|, v116
    s_waitcnt lgkmcnt(6)
    v_lshlrev_b32 v72, 16, v84
    v_and_b32 v9, s70, v84
    v_lshlrev_b32 v17, 16, v85
    v_and_b32 v25, s70, v85
    v_lshlrev_b32 v33, 16, v86
    v_and_b32 v41, s70, v86
    v_lshlrev_b32 v49, 16, v87
    v_and_b32_e64 v57, s70, v87
    v_max3_f32 v116, |v72|, |v9|, v116
    v_max3_f32 v116, |v17|, |v25|, v116
    v_max3_f32 v116, |v33|, |v41|, v116
    v_max3_f32 v116, |v49|, |v57|, v116
    v_lshlrev_b32 v65, 16, v88
    v_and_b32 v73, s70, v88
    v_lshlrev_b32 v10, 16, v89
    v_and_b32 v18, s70, v89
    v_lshlrev_b32 v26, 16, v90
    v_and_b32 v34, s70, v90
    v_lshlrev_b32 v42, 16, v91
    v_and_b32 v50, s70, v91
    v_max3_f32 v116, |v65|, |v73|, v116
    v_max3_f32 v116, |v10|, |v18|, v116
    v_max3_f32 v116, |v26|, |v34|, v116
    v_max3_f32 v116, |v42|, |v50|, v116
    s_waitcnt lgkmcnt(3)
    v_lshlrev_b32 v58, 16, v92
    v_and_b32 v66, s70, v92
    v_lshlrev_b32 v74, 16, v93
    v_and_b32 v11, s70, v93
    v_lshlrev_b32 v19, 16, v94
    v_and_b32 v27, s70, v94
    v_lshlrev_b32 v35, 16, v95
    v_and_b32_e64 v43, s70, v95
    v_max3_f32 v116, |v58|, |v66|, v116
    v_max3_f32 v116, |v74|, |v11|, v116
    v_max3_f32 v116, |v19|, |v27|, v116
    v_max3_f32 v116, |v35|, |v43|, v116
    v_lshlrev_b32 v51, 16, v96
    v_and_b32 v59, s70, v96
    v_lshlrev_b32 v67, 16, v97
    v_and_b32 v75, s70, v97
    v_lshlrev_b32 v12, 16, v98
    v_and_b32 v20, s70, v98
    v_lshlrev_b32 v28, 16, v99
    v_and_b32 v36, s70, v99
    v_max3_f32 v116, |v51|, |v59|, v116
    v_max3_f32 v116, |v67|, |v75|, v116
    v_max3_f32 v116, |v12|, |v20|, v116
    v_max3_f32 v116, |v28|, |v36|, v116
    v_lshlrev_b32 v44, 16, v100
    v_and_b32 v52, s70, v100
    v_lshlrev_b32 v60, 16, v101
    v_and_b32 v68, s70, v101
    v_lshlrev_b32 v76, 16, v102
    v_and_b32 v13, s70, v102
    v_lshlrev_b32 v21, 16, v103
    v_and_b32 v29, s70, v103
    v_max3_f32 v116, |v44|, |v52|, v116
    v_max3_f32 v116, |v60|, |v68|, v116
    v_max3_f32 v116, |v76|, |v13|, v116
    v_max3_f32 v116, |v21|, |v29|, v116
    s_waitcnt lgkmcnt(0)
    v_lshlrev_b32 v37, 16, v104
    v_and_b32 v45, s70, v104
    v_lshlrev_b32 v53, 16, v105
    v_and_b32 v61, s70, v105
    v_lshlrev_b32 v69, 16, v106
    v_and_b32 v77, s70, v106
    v_lshlrev_b32 v14, 16, v107
    v_and_b32_e64 v22, s70, v107
    v_max3_f32 v116, |v37|, |v45|, v116
    v_max3_f32 v116, |v53|, |v61|, v116
    v_max3_f32 v116, |v69|, |v77|, v116
    v_max3_f32 v116, |v14|, |v22|, v116
    v_lshlrev_b32 v30, 16, v108
    v_and_b32 v38, s70, v108
    v_lshlrev_b32 v46, 16, v109
    v_and_b32 v54, s70, v109
    v_lshlrev_b32 v62, 16, v110
    v_and_b32 v70, s70, v110
    v_lshlrev_b32 v78, 16, v111
    v_and_b32 v15, s70, v111
    v_max3_f32 v116, |v30|, |v38|, v116
    v_max3_f32 v116, |v46|, |v54|, v116
    v_max3_f32 v116, |v62|, |v70|, v116
    v_max3_f32 v116, |v78|, |v15|, v116
    v_lshlrev_b32 v23, 16, v112
    v_and_b32 v31, s70, v112
    v_lshlrev_b32 v39, 16, v113
    v_and_b32 v47, s70, v113
    v_lshlrev_b32 v55, 16, v114
    v_and_b32 v63, s70, v114
    v_lshlrev_b32 v71, 16, v115
    v_and_b32 v79, s70, v115
    v_max3_f32 v116, |v23|, |v31|, v116
    v_max3_f32 v116, |v39|, |v47|, v116
    v_max3_f32 v116, |v55|, |v63|, v116
    v_max3_f32 v116, |v71|, |v79|, v116
    v_pk_fma_f32 v[32:33], v[32:33], s[56:57], v[8:9] op_sel_hi:[1,0,1]
    v_pk_fma_f32 v[34:35], v[34:35], s[56:57], v[10:11] op_sel_hi:[1,0,1]
    v_max_f32_dpp v116, v116, v116 row_shr:1 row_mask:0xf bank_mask:0xf bound_ctrl:1
    v_pk_fma_f32 v[36:37], v[36:37], s[56:57], v[12:13] op_sel_hi:[1,0,1]
    v_pk_fma_f32 v[38:39], v[38:39], s[56:57], v[14:15] op_sel_hi:[1,0,1]
    v_max_f32_dpp v116, v116, v116 row_shr:2 row_mask:0xf bank_mask:0xf bound_ctrl:1
    v_pk_fma_f32 v[40:41], v[40:41], s[56:57], v[16:17] op_sel_hi:[1,0,1]
    v_pk_fma_f32 v[42:43], v[42:43], s[56:57], v[18:19] op_sel_hi:[1,0,1]
    v_max_f32_dpp v116, v116, v116 row_shr:4 row_mask:0xf bank_mask:0xf bound_ctrl:1
    v_pk_fma_f32 v[44:45], v[44:45], s[56:57], v[20:21] op_sel_hi:[1,0,1]
    v_pk_fma_f32 v[46:47], v[46:47], s[56:57], v[22:23] op_sel_hi:[1,0,1]
    v_max_f32_dpp v116, v116, v116 row_shr:8 row_mask:0xf bank_mask:0xf bound_ctrl:1
    v_pk_fma_f32 v[48:49], v[48:49], s[56:57], v[24:25] op_sel_hi:[1,0,1]
    v_pk_fma_f32 v[50:51], v[50:51], s[56:57], v[26:27] op_sel_hi:[1,0,1]
    v_max_f32_dpp v116, v116, v116 row_bcast:15 row_mask:0xa bank_mask:0xf
    v_pk_fma_f32 v[52:53], v[52:53], s[56:57], v[28:29] op_sel_hi:[1,0,1]
    v_pk_fma_f32 v[54:55], v[54:55], s[56:57], v[30:31] op_sel_hi:[1,0,1]
    v_max_f32_dpp v116, v116, v116 row_bcast:31 row_mask:0xc bank_mask:0xf
    v_pk_add_f32 v[32:33], v[32:33], v[56:57]
    v_pk_add_f32 v[34:35], v[34:35], v[58:59]
    s_mov_b32 exec_lo, 0
    s_mov_b32 exec_hi, 0x80000000
    ds_write_b32 v117, v116 offset:128
    s_mov_b64 exec, -1
    v_pk_add_f32 v[36:37], v[36:37], v[60:61]
    v_pk_add_f32 v[38:39], v[38:39], v[62:63]
    v_pk_add_f32 v[40:41], v[40:41], v[64:65]
    v_pk_add_f32 v[42:43], v[42:43], v[66:67]
    v_pk_add_f32 v[44:45], v[44:45], v[68:69]
    v_pk_add_f32 v[46:47], v[46:47], v[70:71]
    v_pk_add_f32 v[48:49], v[48:49], v[72:73]
    v_pk_add_f32 v[50:51], v[50:51], v[74:75]
    v_pk_add_f32 v[52:53], v[52:53], v[76:77]
    v_pk_add_f32 v[54:55], v[54:55], v[78:79]
    s_waitcnt lgkmcnt(0)
    s_barrier
    ds_read_b128 v[120:123], v250 offset:128
    v_pk_add_f32 v[80:81], v[32:33], v[48:49]
    v_pk_add_f32 v[82:83], v[34:35], v[50:51]
    v_pk_add_f32 v[84:85], v[36:37], v[52:53]
    v_pk_add_f32 v[86:87], v[38:39], v[54:55]
    v_pk_add_f32 v[32:33], v[80:81], v[40:41]
    v_pk_add_f32 v[40:41], v[80:81], v[40:41] neg_lo:[0,1] neg_hi:[0,1]
    v_pk_add_f32 v[34:35], v[82:83], v[42:43]
    v_pk_add_f32 v[42:43], v[82:83], v[42:43] neg_lo:[0,1] neg_hi:[0,1]
    v_pk_add_f32 v[36:37], v[84:85], v[44:45]
    v_pk_add_f32 v[44:45], v[84:85], v[44:45] neg_lo:[0,1] neg_hi:[0,1]
    v_pk_add_f32 v[38:39], v[86:87], v[46:47]
    v_pk_add_f32 v[46:47], v[86:87], v[46:47] neg_lo:[0,1] neg_hi:[0,1]
    s_bitcmp1_b32 s52, 0
    s_cbranch_scc1 Ljp1
    v_pk_add_f32 v[80:81], v[8:9], v[24:25]
    v_pk_add_f32 v[82:83], v[10:11], v[26:27]
    v_pk_add_f32 v[84:85], v[12:13], v[28:29]
    v_pk_add_f32 v[86:87], v[14:15], v[30:31]
    v_pk_add_f32 v[8:9], v[80:81], v[16:17]
    v_pk_add_f32 v[16:17], v[80:81], v[16:17] neg_lo:[0,1] neg_hi:[0,1]
    v_pk_add_f32 v[10:11], v[82:83], v[18:19]
    v_pk_add_f32 v[18:19], v[82:83], v[18:19] neg_lo:[0,1] neg_hi:[0,1]
    v_pk_add_f32 v[12:13], v[84:85], v[20:21]
    v_pk_add_f32 v[20:21], v[84:85], v[20:21] neg_lo:[0,1] neg_hi:[0,1]
    v_pk_add_f32 v[14:15], v[86:87], v[22:23]
    v_pk_add_f32 v[22:23], v[86:87], v[22:23] neg_lo:[0,1] neg_hi:[0,1]
    s_branch Ljp2
Ljp1:
    s_nop 0
    v_pk_add_f32 v[80:81], v[56:57], v[72:73]
    v_pk_add_f32 v[82:83], v[58:59], v[74:75]
    v_pk_add_f32 v[84:85], v[60:61], v[76:77]
    v_pk_add_f32 v[86:87], v[62:63], v[78:79]
    v_pk_add_f32 v[8:9], v[80:81], v[64:65]
    v_pk_add_f32 v[16:17], v[80:81], v[64:65] neg_lo:[0,1] neg_hi:[0,1]
    v_pk_add_f32 v[10:11], v[82:83], v[66:67]
    v_pk_add_f32 v[18:19], v[82:83], v[66:67] neg_lo:[0,1] neg_hi:[0,1]
    v_pk_add_f32 v[12:13], v[84:85], v[68:69]
    v_pk_add_f32 v[20:21], v[84:85], v[68:69] neg_lo:[0,1] neg_hi:[0,1]
    v_pk_add_f32 v[14:15], v[86:87], v[70:71]
    v_pk_add_f32 v[22:23], v[86:87], v[70:71] neg_lo:[0,1] neg_hi:[0,1]
    v_pk_mul_f32 v[24:25], v[72:73], 1.0 op_sel_hi:[1,0]
    v_pk_mul_f32 v[26:27], v[74:75], 1.0 op_sel_hi:[1,0]
    v_pk_mul_f32 v[28:29], v[76:77], 1.0 op_sel_hi:[1,0]
    v_pk_mul_f32 v[30:31], v[78:79], 1.0 op_sel_hi:[1,0]
Ljp2:
    s_cmp_lg_u32 s3, 0
    s_cbranch_scc1 Ljob_mid
    buffer_load_dwordx4 v[232:235], v251, s[28:31], s25 offen sc1
Ljob_mid:
    s_waitcnt lgkmcnt(0)
    v_max3_f32 v120, v120, v121, v122
    v_max_f32 v120, v120, v123
    v_frexp_exp_i32_f32 v120, v120
    v_min_i32 v120, 60, v120
    v_max_i32 v120, 0xffffffc4, v120
    v_add_u32 v116, 119, v120
    v_lshlrev_b32_e64 v116, 23, v116
    v_sub_u32 v88, 135, v120
    v_lshlrev_b32 v88, 23, v88
    v_readfirstlane_b32 s64, v116
    v_mul_f32 v90, 0x47000080, v88
    v_mul_f32 v91, 0xc7000000, v88
    v_pk_mul_f32 v[92:93], v[90:91], 0.5 op_sel_hi:[1,0]
    v_pk_mul_f32 v[80:81], v[24:25], v[88:89] op_sel_hi:[1,0]
    v_pk_mul_f32 v[82:83], v[26:27], v[88:89] op_sel_hi:[1,0]
    v_pk_mul_f32 v[84:85], v[28:29], v[88:89] op_sel_hi:[1,0]
    v_pk_mul_f32 v[86:87], v[30:31], v[88:89] op_sel_hi:[1,0]
    v_cvt_pk_f16_f32 v56, v80, v81
    v_cvt_pk_f16_f32 v57, v82, v83
    v_cvt_pk_f16_f32 v58, v84, v85
    v_cvt_pk_f16_f32 v59, v86, v87
    buffer_store_dwordx4 v[56:59], v236, s[28:31], s68 offen sc1
    s_add_u32 s68, s68, 0x1000
    v_pk_mul_f32 v[80:81], v[8:9], v[90:91] op_sel_hi:[1,0]
    v_pk_mul_f32 v[82:83], v[10:11], v[90:91] op_sel_hi:[1,0]
    v_pk_mul_f32 v[84:85], v[12:13], v[90:91] op_sel_hi:[1,0]
    v_pk_mul_f32 v[86:87], v[14:15], v[90:91] op_sel_hi:[1,0]
    v_pk_fma_f32 v[80:81], v[8:9], v[90:91], v[80:81] op_sel:[0,1,0] op_sel_hi:[1,1,1]
    v_pk_fma_f32 v[82:83], v[10:11], v[90:91], v[82:83] op_sel:[0,1,0] op_sel_hi:[1,1,1]
    v_pk_fma_f32 v[84:85], v[12:13], v[90:91], v[84:85] op_sel:[0,1,0] op_sel_hi:[1,1,1]
    v_pk_fma_f32 v[86:87], v[14:15], v[90:91], v[86:87] op_sel:[0,1,0] op_sel_hi:[1,1,1]
    v_cvt_pk_f16_f32 v60, v80, v81
    v_cvt_pk_f16_f32 v61, v82, v83
    v_cvt_pk_f16_f32 v62, v84, v85
    v_cvt_pk_f16_f32 v63, v86, v87
    buffer_store_dwordx4 v[60:63], v236, s[28:31], s68 offen sc1
    s_add_u32 s68, s68, 0x1000
    v_pk_mul_f32 v[80:81], v[16:17], v[90:91] op_sel_hi:[1,0]
    v_pk_mul_f32 v[82:83], v[18:19], v[90:91] op_sel_hi:[1,0]
    v_pk_mul_f32 v[84:85], v[20:21], v[90:91] op_sel_hi:[1,0]
    v_pk_mul_f32 v[86:87], v[22:23], v[90:91] op_sel_hi:[1,0]
    v_pk_fma_f32 v[80:81], v[16:17], v[90:91], v[80:81] op_sel:[0,1,0] op_sel_hi:[1,1,1]
    v_pk_fma_f32 v[82:83], v[18:19], v[90:91], v[82:83] op_sel:[0,1,0] op_sel_hi:[1,1,1]
    v_pk_fma_f32 v[84:85], v[20:21], v[90:91], v[84:85] op_sel:[0,1,0] op_sel_hi:[1,1,1]
    v_pk_fma_f32 v[86:87], v[22:23], v[90:91], v[86:87] op_sel:[0,1,0] op_sel_hi:[1,1,1]
    v_cvt_pk_f16_f32 v64, v80, v81
    v_cvt_pk_f16_f32 v65, v82, v83
    v_cvt_pk_f16_f32 v66, v84, v85
    v_cvt_pk_f16_f32 v67, v86, v87
    buffer_store_dwordx4 v[64:67], v236, s[28:31], s68 offen sc1
    s_add_u32 s68, s68, 0x606000
    v_pk_mul_f32 v[80:81], v[48:49], v[90:91] op_sel_hi:[1,0]
    v_pk_mul_f32 v[82:83], v[50:51], v[90:91] op_sel_hi:[1,0]
    v_pk_mul_f32 v[84:85], v[52:53], v[90:91] op_sel_hi:[1,0]
    v_pk_mul_f32 v[86:87], v[54:55], v[90:91] op_sel_hi:[1,0]
    v_pk_fma_f32 v[80:81], v[48:49], v[90:91], v[80:81] op_sel:[0,1,0] op_sel_hi:[1,1,1]
    v_pk_fma_f32 v[82:83], v[50:51], v[90:91], v[82:83] op_sel:[0,1,0] op_sel_hi:[1,1,1]
    v_pk_fma_f32 v[84:85], v[52:53], v[90:91], v[84:85] op_sel:[0,1,0] op_sel_hi:[1,1,1]
    v_pk_fma_f32 v[86:87], v[54:55], v[90:91], v[86:87] op_sel:[0,1,0] op_sel_hi:[1,1,1]
    v_cvt_pk_f16_f32 v68, v80, v81
    v_cvt_pk_f16_f32 v69, v82, v83
    v_cvt_pk_f16_f32 v70, v84, v85
    v_cvt_pk_f16_f32 v71, v86, v87
    buffer_store_dwordx4 v[68:71], v236, s[28:31], s69 offen sc1
    s_add_u32 s69, s69, 0x1000
    v_pk_mul_f32 v[80:81], v[32:33], v[92:93] op_sel_hi:[1,0]
    v_pk_mul_f32 v[82:83], v[34:35], v[92:93] op_sel_hi:[1,0]
    v_pk_mul_f32 v[84:85], v[36:37], v[92:93] op_sel_hi:[1,0]
    v_pk_mul_f32 v[86:87], v[38:39], v[92:93] op_sel_hi:[1,0]
    v_pk_fma_f32 v[80:81], v[32:33], v[92:93], v[80:81] op_sel:[0,1,0] op_sel_hi:[1,1,1]
    v_pk_fma_f32 v[82:83], v[34:35], v[92:93], v[82:83] op_sel:[0,1,0] op_sel_hi:[1,1,1]
    v_pk_fma_f32 v[84:85], v[36:37], v[92:93], v[84:85] op_sel:[0,1,0] op_sel_hi:[1,1,1]
    v_pk_fma_f32 v[86:87], v[38:39], v[92:93], v[86:87] op_sel:[0,1,0] op_sel_hi:[1,1,1]
    v_cvt_pk_f16_f32 v72, v80, v81
    v_cvt_pk_f16_f32 v73, v82, v83
    v_cvt_pk_f16_f32 v74, v84, v85
    v_cvt_pk_f16_f32 v75, v86, v87
    buffer_store_dwordx4 v[72:75], v236, s[28:31], s69 offen sc1
    s_add_u32 s69, s69, 0x1000
    v_pk_mul_f32 v[80:81], v[40:41], v[92:93] op_sel_hi:[1,0]
    v_pk_mul_f32 v[82:83], v[42:43], v[92:93] op_sel_hi:[1,0]
    v_pk_mul_f32 v[84:85], v[44:45], v[92:93] op_sel_hi:[1,0]
    v_pk_mul_f32 v[86:87], v[46:47], v[92:93] op_sel_hi:[1,0]
    v_pk_fma_f32 v[80:81], v[40:41], v[92:93], v[80:81] op_sel:[0,1,0] op_sel_hi:[1,1,1]
    v_pk_fma_f32 v[82:83], v[42:43], v[92:93], v[82:83] op_sel:[0,1,0] op_sel_hi:[1,1,1]
    v_pk_fma_f32 v[84:85], v[44:45], v[92:93], v[84:85] op_sel:[0,1,0] op_sel_hi:[1,1,1]
    v_pk_fma_f32 v[86:87], v[46:47], v[92:93], v[86:87] op_sel:[0,1,0] op_sel_hi:[1,1,1]
    v_cvt_pk_f16_f32 v76, v80, v81
    v_cvt_pk_f16_f32 v77, v82, v83
    v_cvt_pk_f16_f32 v78, v84, v85
    v_cvt_pk_f16_f32 v79, v86, v87
    buffer_store_dwordx4 v[76:79], v236, s[28:31], s69 offen sc1
    s_add_u32 s69, s69, 0x606000
    s_cmp_lg_u32 s3, 0
    s_cbranch_scc1 Ljoin
    s_mov_b32 s58, 400000
    s_waitcnt vmcnt(6)
    s_branch Ls_chk
Ls_poll:
    buffer_load_dwordx4 v[232:235], v251, s[28:31], s25 offen sc1
Ls_wait:
    s_waitcnt vmcnt(0)
Ls_chk:
    v_cmp_ne_u32 vcc, s61, v233
    v_cmp_ne_u32 s[56:57], s61, v235
    s_nop 1
    s_or_b32 s56, s56, vcc_lo
    s_cbranch_scc0 Ls_ok
    s_sub_u32 s58, s58, 1
    s_cmp_lg_u32 s58, 0
    s_cbranch_scc1 Ls_poll
Ls_ok:
    s_nop 0
    v_add_f32_dpp v232, v232, v232 row_shr:1 row_mask:0xf bank_mask:0xf bound_ctrl:1
    v_add_f32_dpp v234, v234, v234 row_shr:1 row_mask:0xf bank_mask:0xf bound_ctrl:1
    s_nop 0
    v_add_f32_dpp v232, v232, v232 row_shr:2 row_mask:0xf bank_mask:0xf bound_ctrl:1
    v_add_f32_dpp v234, v234, v234 row_shr:2 row_mask:0xf bank_mask:0xf bound_ctrl:1
    s_nop 0
    v_add_f32_dpp v232, v232, v232 row_shr:4 row_mask:0xf bank_mask:0xf bound_ctrl:1
    v_add_f32_dpp v234, v234, v234 row_shr:4 row_mask:0xf bank_mask:0xf bound_ctrl:1
    s_nop 0
    v_add_f32_dpp v232, v232, v232 row_shr:8 row_mask:0xf bank_mask:0xf bound_ctrl:1
    v_add_f32_dpp v234, v234, v234 row_shr:8 row_mask:0xf bank_mask:0xf bound_ctrl:1
    s_nop 0
    v_add_f32_dpp v232, v232, v232 row_bcast:15 row_mask:0xa bank_mask:0xf
    v_add_f32_dpp v234, v234, v234 row_bcast:15 row_mask:0xa bank_mask:0xf
    s_nop 0
    v_add_f32_dpp v232, v232, v232 row_bcast:31 row_mask:0xc bank_mask:0xf
    v_add_f32_dpp v234, v234, v234 row_bcast:31 row_mask:0xc bank_mask:0xf
    v_mul_f32 v232, 0xb6000000, v232
    v_mul_f32 v234, 0x36000000, v234
    v_fma_f32 v234, -v232, v232, v234
    v_max_f32_e64 v234, 0, v234
    v_add_f32 v234, 0x3727c5ac, v234
    v_rsq_f32 v233, v234
    s_mov_b32 exec_lo, 0
    s_mov_b32 exec_hi, 0x80000000
    ds_write_b64 v250, v[232:233] offset:64
    s_mov_b64 exec, -1
Ljoin:
    ds_read_b64 v[24:25], v250 offset:72
    s_mov_b32 s56, 0xbfb8aa3b
    s_waitcnt vmcnt(6)
    v_lshlrev_b32 v8, 16, v124
    v_and_b32 v9, s70, v124
    v_lshlrev_b32 v16, 16, v128
    v_and_b32 v17, s70, v128
    v_lshlrev_b32 v10, 16, v125
    v_and_b32 v11, s70, v125
    v_lshlrev_b32 v18, 16, v129
    v_and_b32 v19, s70, v129
    v_lshlrev_b32 v12, 16, v126
    v_and_b32 v13, s70, v126
    v_lshlrev_b32 v20, 16, v130
    v_and_b32 v21, s70, v130
    v_lshlrev_b32 v14, 16, v127
    v_and_b32 v15, s70, v127
    v_lshlrev_b32 v22, 16, v131
    v_and_b32 v23, s70, v131
    s_cmp_lg_u32 s60, 0
    s_cselect_b64 vcc, -1, 0
    s_waitcnt lgkmcnt(0)
    s_barrier
    ds_read_b64 v[232:233], v250 offset:64
    v_cndmask_b32_e64 v24, v24, v25, vcc
    v_add_u32 v24, 124, v24
    v_lshlrev_b32_e64 v24, 23, v24
    v_pk_mul_f32 v[8:9], v[8:9], s[56:57] op_sel_hi:[1,0]
    v_pk_mul_f32 v[10:11], v[10:11], s[56:57] op_sel_hi:[1,0]
    v_pk_mul_f32 v[12:13], v[12:13], s[56:57] op_sel_hi:[1,0]
    v_pk_mul_f32 v[14:15], v[14:15], s[56:57] op_sel_hi:[1,0]
    v_pk_mul_f32 v[16:17], v[16:17], s[56:57] op_sel_hi:[1,0]
    v_pk_mul_f32 v[18:19], v[18:19], s[56:57] op_sel_hi:[1,0]
    v_pk_mul_f32 v[20:21], v[20:21], s[56:57] op_sel_hi:[1,0]
    v_pk_mul_f32 v[22:23], v[22:23], s[56:57] op_sel_hi:[1,0]
    v_readfirstlane_b32 s63, v24
    v_mul_f32 v25, s56, v24
    v_mul_f32 v24, s56, v24
    s_waitcnt lgkmcnt(0)
    v_pk_mul_f32 v[8:9], v[8:9], v[232:233] op_sel:[0,1] op_sel_hi:[1,1]
    v_pk_mul_f32 v[10:11], v[10:11], v[232:233] op_sel:[0,1] op_sel_hi:[1,1]
    v_pk_mul_f32 v[12:13], v[12:13], v[232:233] op_sel:[0,1] op_sel_hi:[1,1]
    v_pk_mul_f32 v[14:15], v[14:15], v[232:233] op_sel:[0,1] op_sel_hi:[1,1]
    v_pk_fma_f32 v[16:17], v[8:9], v[232:233], v[16:17] op_sel_hi:[1,0,1]
    v_pk_fma_f32 v[18:19], v[10:11], v[232:233], v[18:19] op_sel_hi:[1,0,1]
    v_pk_fma_f32 v[20:21], v[12:13], v[232:233], v[20:21] op_sel_hi:[1,0,1]
    v_pk_fma_f32 v[22:23], v[14:15], v[232:233], v[22:23] op_sel_hi:[1,0,1]
    v_mov_b32 v252, s61
    v_mov_b32 v253, s61
    s_lshl_b32 s59, s60, 16
    s_add_u32 s57, s59, s12
    s_lshl_b32 s56, s3, 4
    s_add_u32 s56, s56, s57
    s_add_u32 s65, s56, 0x60000
    v_pk_fma_f32 v[136:137], v[136:137], v[8:9], v[16:17]
    v_pk_fma_f32 v[138:139], v[138:139], v[10:11], v[18:19]
    v_pk_fma_f32 v[140:141], v[140:141], v[12:13], v[20:21]
    v_pk_fma_f32 v[142:143], v[142:143], v[14:15], v[22:23]
    v_exp_f32 v32, v136
    v_exp_f32 v33, v137
    v_exp_f32 v34, v138
    v_exp_f32 v35, v139
    v_exp_f32 v36, v140
    v_exp_f32 v37, v141
    v_exp_f32 v38, v142
    v_exp_f32 v39, v143
    v_pk_fma_f32 v[32:33], v[32:33], v[24:25], v[24:25]
    v_pk_fma_f32 v[34:35], v[34:35], v[24:25], v[24:25]
    v_pk_fma_f32 v[36:37], v[36:37], v[24:25], v[24:25]
    v_pk_fma_f32 v[38:39], v[38:39], v[24:25], v[24:25]
    v_rcp_f32 v32, v32
    v_rcp_f32 v33, v33
    v_rcp_f32 v34, v34
    v_rcp_f32 v35, v35
    v_rcp_f32 v36, v36
    v_rcp_f32 v37, v37
    v_rcp_f32 v38, v38
    v_rcp_f32 v39, v39
    v_pk_mul_f32 v[136:137], v[136:137], v[32:33]
    v_pk_mul_f32 v[138:139], v[138:139], v[34:35]
    v_pk_mul_f32 v[140:141], v[140:141], v[36:37]
    v_pk_mul_f32 v[142:143], v[142:143], v[38:39]
    v_cvt_pk_f16_f32 v80, v136, v137
    v_cvt_pk_f16_f32 v81, v138, v139
    v_cvt_pk_f16_f32 v82, v140, v141
    v_cvt_pk_f16_f32 v83, v142, v143
    v_add_u32 v80, 0x40004, v80
    v_add_u32 v81, 0x40004, v81
    v_add_u32 v82, 0x40004, v82
    v_add_u32 v83, 0x40004, v83
    v_and_b32 v80, 0xfff8fff8, v80
    v_and_b32 v81, 0xfff8fff8, v81
    v_and_b32 v82, 0xfff8fff8, v82
    v_and_b32 v83, 0xfff8fff8, v83
    buffer_store_dwordx4 v[80:83], v246, s[28:31], s66 offen offset:0 sc1
    v_pk_fma_f32 v[144:145], v[144:145], v[8:9], v[16:17]
    v_pk_fma_f32 v[146:147], v[146:147], v[10:11], v[18:19]
    v_pk_fma_f32 v[148:149], v[148:149], v[12:13], v[20:21]
    v_pk_fma_f32 v[150:151], v[150:151], v[14:15], v[22:23]
    v_exp_f32 v40, v144
    v_exp_f32 v41, v145
    v_exp_f32 v42, v146
    v_exp_f32 v43, v147
    v_exp_f32 v44, v148
    v_exp_f32 v45, v149
    v_exp_f32 v46, v150
    v_exp_f32 v47, v151
    v_pk_fma_f32 v[40:41], v[40:41], v[24:25], v[24:25]
    v_pk_fma_f32 v[42:43], v[42:43], v[24:25], v[24:25]
    v_pk_fma_f32 v[44:45], v[44:45], v[24:25], v[24:25]
    v_pk_fma_f32 v[46:47], v[46:47], v[24:25], v[24:25]
    v_rcp_f32 v40, v40
    v_rcp_f32 v41, v41
    v_rcp_f32 v42, v42
    v_rcp_f32 v43, v43
    v_rcp_f32 v44, v44
    v_rcp_f32 v45, v45
    v_rcp_f32 v46, v46
    v_rcp_f32 v47, v47
    v_pk_mul_f32 v[144:145], v[144:145], v[40:41]
    v_pk_mul_f32 v[146:147], v[146:147], v[42:43]
    v_pk_mul_f32 v[148:149], v[148:149], v[44:45]
    v_pk_mul_f32 v[150:151], v[150:151], v[46:47]
    v_cvt_pk_f16_f32 v84, v144, v145
    v_cvt_pk_f16_f32 v85, v146, v147
    v_cvt_pk_f16_f32 v86, v148, v149
    v_cvt_pk_f16_f32 v87, v150, v151
    v_add_u32 v84, 0x40004, v84
    v_add_u32 v85, 0x40004, v85
    v_add_u32 v86, 0x40004, v86
    v_add_u32 v87, 0x40004, v87
    v_and_b32 v84, 0xfff8fff8, v84
    v_and_b32 v85, 0xfff8fff8, v85
    v_and_b32 v86, 0xfff8fff8, v86
    v_and_b32 v87, 0xfff8fff8, v87
    buffer_store_dwordx4 v[84:87], v246, s[28:31], s66 offen offset:256 sc1
    v_pk_fma_f32 v[152:153], v[152:153], v[8:9], v[16:17]
    v_pk_fma_f32 v[154:155], v[154:155], v[10:11], v[18:19]
    v_pk_fma_f32 v[156:157], v[156:157], v[12:13], v[20:21]
    v_pk_fma_f32 v[158:159], v[158:159], v[14:15], v[22:23]
    v_exp_f32 v32, v152
    v_exp_f32 v33, v153
    v_exp_f32 v34, v154
    v_exp_f32 v35, v155
    v_exp_f32 v36, v156
    v_exp_f32 v37, v157
    v_exp_f32 v38, v158
    v_exp_f32 v39, v159
    v_pk_fma_f32 v[32:33], v[32:33], v[24:25], v[24:25]
    v_pk_fma_f32 v[34:35], v[34:35], v[24:25], v[24:25]
    v_pk_fma_f32 v[36:37], v[36:37], v[24:25], v[24:25]
    v_pk_fma_f32 v[38:39], v[38:39], v[24:25], v[24:25]
    v_rcp_f32 v32, v32
    v_rcp_f32 v33, v33
    v_rcp_f32 v34, v34
    v_rcp_f32 v35, v35
    v_rcp_f32 v36, v36
    v_rcp_f32 v37, v37
    v_rcp_f32 v38, v38
    v_rcp_f32 v39, v39
    v_pk_mul_f32 v[152:153], v[152:153], v[32:33]
    v_pk_mul_f32 v[154:155], v[154:155], v[34:35]
    v_pk_mul_f32 v[156:157], v[156:157], v[36:37]
    v_pk_mul_f32 v[158:159], v[158:159], v[38:39]
    v_cvt_pk_f16_f32 v88, v152, v153
    v_cvt_pk_f16_f32 v89, v154, v155
    v_cvt_pk_f16_f32 v90, v156, v157
    v_cvt_pk_f16_f32 v91, v158, v159
    v_add_u32 v88, 0x40004, v88
    v_add_u32 v89, 0x40004, v89
    v_add_u32 v90, 0x40004, v90
    v_add_u32 v91, 0x40004, v91
    v_and_b32 v88, 0xfff8fff8, v88
    v_and_b32 v89, 0xfff8fff8, v89
    v_and_b32 v90, 0xfff8fff8, v90
    v_and_b32 v91, 0xfff8fff8, v91
    buffer_store_dwordx4 v[88:91], v246, s[28:31], s66 offen offset:512 sc1
    v_pk_fma_f32 v[160:161], v[160:161], v[8:9], v[16:17]
    v_pk_fma_f32 v[162:163], v[162:163], v[10:11], v[18:19]
    v_pk_fma_f32 v[164:165], v[164:165], v[12:13], v[20:21]
    v_pk_fma_f32 v[166:167], v[166:167], v[14:15], v[22:23]
    v_exp_f32 v40, v160
    v_exp_f32 v41, v161
    v_exp_f32 v42, v162
    v_exp_f32 v43, v163
    v_exp_f32 v44, v164
    v_exp_f32 v45, v165
    v_exp_f32 v46, v166
    v_exp_f32 v47, v167
    v_pk_fma_f32 v[40:41], v[40:41], v[24:25], v[24:25]
    v_pk_fma_f32 v[42:43], v[42:43], v[24:25], v[24:25]
    v_pk_fma_f32 v[44:45], v[44:45], v[24:25], v[24:25]
    v_pk_fma_f32 v[46:47], v[46:47], v[24:25], v[24:25]
    v_rcp_f32 v40, v40
    v_rcp_f32 v41, v41
    v_rcp_f32 v42, v42
    v_rcp_f32 v43, v43
    v_rcp_f32 v44, v44
    v_rcp_f32 v45, v45
    v_rcp_f32 v46, v46
    v_rcp_f32 v47, v47
    v_pk_mul_f32 v[160:161], v[160:161], v[40:41]
    v_pk_mul_f32 v[162:163], v[162:163], v[42:43]
    v_pk_mul_f32 v[164:165], v[164:165], v[44:45]
    v_pk_mul_f32 v[166:167], v[166:167], v[46:47]
    v_cvt_pk_f16_f32 v92, v160, v161
    v_cvt_pk_f16_f32 v93, v162, v163
    v_cvt_pk_f16_f32 v94, v164, v165
    v_cvt_pk_f16_f32 v95, v166, v167
    v_add_u32 v92, 0x40004, v92
    v_add_u32 v93, 0x40004, v93
    v_add_u32 v94, 0x40004, v94
    v_add_u32 v95, 0x40004, v95
    v_and_b32 v92, 0xfff8fff8, v92
    v_and_b32 v93, 0xfff8fff8, v93
    v_and_b32 v94, 0xfff8fff8, v94
    v_and_b32 v95, 0xfff8fff8, v95
    buffer_store_dwordx4 v[92:95], v246, s[28:31], s66 offen offset:768 sc1
    v_mov_b32 v128, s61
    v_mov_b32 v129, s61
    v_mov_b32 v130, s64
    s_waitcnt vmcnt(4)
    buffer_store_dwordx4 v[128:131], v249, s[28:31], s65 offen sc1
    v_pk_fma_f32 v[168:169], v[168:169], v[8:9], v[16:17]
    v_pk_fma_f32 v[170:171], v[170:171], v[10:11], v[18:19]
    v_pk_fma_f32 v[172:173], v[172:173], v[12:13], v[20:21]
    v_pk_fma_f32 v[174:175], v[174:175], v[14:15], v[22:23]
    v_exp_f32 v32, v168
    v_exp_f32 v33, v169
    v_exp_f32 v34, v170
    v_exp_f32 v35, v171
    v_exp_f32 v36, v172
    v_exp_f32 v37, v173
    v_exp_f32 v38, v174
    v_exp_f32 v39, v175
    v_pk_fma_f32 v[32:33], v[32:33], v[24:25], v[24:25]
    v_pk_fma_f32 v[34:35], v[34:35], v[24:25], v[24:25]
    v_pk_fma_f32 v[36:37], v[36:37], v[24:25], v[24:25]
    v_pk_fma_f32 v[38:39], v[38:39], v[24:25], v[24:25]
    v_rcp_f32 v32, v32
    v_rcp_f32 v33, v33
    v_rcp_f32 v34, v34
    v_rcp_f32 v35, v35
    v_rcp_f32 v36, v36
    v_rcp_f32 v37, v37
    v_rcp_f32 v38, v38
    v_rcp_f32 v39, v39
    v_pk_mul_f32 v[168:169], v[168:169], v[32:33]
    v_pk_mul_f32 v[170:171], v[170:171], v[34:35]
    v_pk_mul_f32 v[172:173], v[172:173], v[36:37]
    v_pk_mul_f32 v[174:175], v[174:175], v[38:39]
    v_cvt_pk_f16_f32 v96, v168, v169
    v_cvt_pk_f16_f32 v97, v170, v171
    v_cvt_pk_f16_f32 v98, v172, v173
    v_cvt_pk_f16_f32 v99, v174, v175
    v_add_u32 v96, 0x40004, v96
    v_add_u32 v97, 0x40004, v97
    v_add_u32 v98, 0x40004, v98
    v_add_u32 v99, 0x40004, v99
    v_and_b32 v96, 0xfff8fff8, v96
    v_and_b32 v97, 0xfff8fff8, v97
    v_and_b32 v98, 0xfff8fff8, v98
    v_and_b32 v99, 0xfff8fff8, v99
    buffer_store_dwordx4 v[96:99], v246, s[28:31], s67 offen offset:0 sc1
    v_pk_fma_f32 v[176:177], v[176:177], v[8:9], v[16:17]
    v_pk_fma_f32 v[178:179], v[178:179], v[10:11], v[18:19]
    v_pk_fma_f32 v[180:181], v[180:181], v[12:13], v[20:21]
    v_pk_fma_f32 v[182:183], v[182:183], v[14:15], v[22:23]
    v_exp_f32 v40, v176
    v_exp_f32 v41, v177
    v_exp_f32 v42, v178
    v_exp_f32 v43, v179
    v_exp_f32 v44, v180
    v_exp_f32 v45, v181
    v_exp_f32 v46, v182
    v_exp_f32 v47, v183
    v_pk_fma_f32 v[40:41], v[40:41], v[24:25], v[24:25]
    v_pk_fma_f32 v[42:43], v[42:43], v[24:25], v[24:25]
    v_pk_fma_f32 v[44:45], v[44:45], v[24:25], v[24:25]
    v_pk_fma_f32 v[46:47], v[46:47], v[24:25], v[24:25]
    v_rcp_f32 v40, v40
    v_rcp_f32 v41, v41
    v_rcp_f32 v42, v42
    v_rcp_f32 v43, v43
    v_rcp_f32 v44, v44
    v_rcp_f32 v45, v45
    v_rcp_f32 v46, v46
    v_rcp_f32 v47, v47
    v_pk_mul_f32 v[176:177], v[176:177], v[40:41]
    v_pk_mul_f32 v[178:179], v[178:179], v[42:43]
    v_pk_mul_f32 v[180:181], v[180:181], v[44:45]
    v_pk_mul_f32 v[182:183], v[182:183], v[46:47]
    v_cvt_pk_f16_f32 v100, v176, v177
    v_cvt_pk_f16_f32 v101, v178, v179
    v_cvt_pk_f16_f32 v102, v180, v181
    v_cvt_pk_f16_f32 v103, v182, v183
    v_add_u32 v100, 0x40004, v100
    v_add_u32 v101, 0x40004, v101
    v_add_u32 v102, 0x40004, v102
    v_add_u32 v103, 0x40004, v103
    v_and_b32 v100, 0xfff8fff8, v100
    v_and_b32 v101, 0xfff8fff8, v101
    v_and_b32 v102, 0xfff8fff8, v102
    v_and_b32 v103, 0xfff8fff8, v103
    buffer_store_dwordx4 v[100:103], v246, s[28:31], s67 offen offset:256 sc1
    v_pk_fma_f32 v[184:185], v[184:185], v[8:9], v[16:17]
    v_pk_fma_f32 v[186:187], v[186:187], v[10:11], v[18:19]
    v_pk_fma_f32 v[188:189], v[188:189], v[12:13], v[20:21]
    v_pk_fma_f32 v[190:191], v[190:191], v[14:15], v[22:23]
    v_exp_f32 v32, v184
    v_exp_f32 v33, v185
    v_exp_f32 v34, v186
    v_exp_f32 v35, v187
    v_exp_f32 v36, v188
    v_exp_f32 v37, v189
    v_exp_f32 v38, v190
    v_exp_f32 v39, v191
    v_pk_fma_f32 v[32:33], v[32:33], v[24:25], v[24:25]
    v_pk_fma_f32 v[34:35], v[34:35], v[24:25], v[24:25]
    v_pk_fma_f32 v[36:37], v[36:37], v[24:25], v[24:25]
    v_pk_fma_f32 v[38:39], v[38:39], v[24:25], v[24:25]
    v_rcp_f32 v32, v32
    v_rcp_f32 v33, v33
    v_rcp_f32 v34, v34
    v_rcp_f32 v35, v35
    v_rcp_f32 v36, v36
    v_rcp_f32 v37, v37
    v_rcp_f32 v38, v38
    v_rcp_f32 v39, v39
    v_pk_mul_f32 v[184:185], v[184:185], v[32:33]
    v_pk_mul_f32 v[186:187], v[186:187], v[34:35]
    v_pk_mul_f32 v[188:189], v[188:189], v[36:37]
    v_pk_mul_f32 v[190:191], v[190:191], v[38:39]
    v_cvt_pk_f16_f32 v104, v184, v185
    v_cvt_pk_f16_f32 v105, v186, v187
    v_cvt_pk_f16_f32 v106, v188, v189
    v_cvt_pk_f16_f32 v107, v190, v191
    v_add_u32 v104, 0x40004, v104
    v_add_u32 v105, 0x40004, v105
    v_add_u32 v106, 0x40004, v106
    v_add_u32 v107, 0x40004, v107
    v_and_b32 v104, 0xfff8fff8, v104
    v_and_b32 v105, 0xfff8fff8, v105
    v_and_b32 v106, 0xfff8fff8, v106
    v_and_b32 v107, 0xfff8fff8, v107
    buffer_store_dwordx4 v[104:107], v246, s[28:31], s67 offen offset:512 sc1
    v_pk_fma_f32 v[192:193], v[192:193], v[8:9], v[16:17]
    v_pk_fma_f32 v[194:195], v[194:195], v[10:11], v[18:19]
    v_pk_fma_f32 v[196:197], v[196:197], v[12:13], v[20:21]
    v_pk_fma_f32 v[198:199], v[198:199], v[14:15], v[22:23]
    v_exp_f32 v40, v192
    v_exp_f32 v41, v193
    v_exp_f32 v42, v194
    v_exp_f32 v43, v195
    v_exp_f32 v44, v196
    v_exp_f32 v45, v197
    v_exp_f32 v46, v198
    v_exp_f32 v47, v199
    v_pk_fma_f32 v[40:41], v[40:41], v[24:25], v[24:25]
    v_pk_fma_f32 v[42:43], v[42:43], v[24:25], v[24:25]
    v_pk_fma_f32 v[44:45], v[44:45], v[24:25], v[24:25]
    v_pk_fma_f32 v[46:47], v[46:47], v[24:25], v[24:25]
    v_rcp_f32 v40, v40
    v_rcp_f32 v41, v41
    v_rcp_f32 v42, v42
    v_rcp_f32 v43, v43
    v_rcp_f32 v44, v44
    v_rcp_f32 v45, v45
    v_rcp_f32 v46, v46
    v_rcp_f32 v47, v47
    v_pk_mul_f32 v[192:193], v[192:193], v[40:41]
    v_pk_mul_f32 v[194:195], v[194:195], v[42:43]
    v_pk_mul_f32 v[196:197], v[196:197], v[44:45]
    v_pk_mul_f32 v[198:199], v[198:199], v[46:47]
    v_cvt_pk_f16_f32 v108, v192, v193
    v_cvt_pk_f16_f32 v109, v194, v195
    v_cvt_pk_f16_f32 v110, v196, v197
    v_cvt_pk_f16_f32 v111, v198, v199
    v_add_u32 v108, 0x40004, v108
    v_add_u32 v109, 0x40004, v109
    v_add_u32 v110, 0x40004, v110
    v_add_u32 v111, 0x40004, v111
    v_and_b32 v108, 0xfff8fff8, v108
    v_and_b32 v109, 0xfff8fff8, v109
    v_and_b32 v110, 0xfff8fff8, v110
    v_and_b32 v111, 0xfff8fff8, v111
    buffer_store_dwordx4 v[108:111], v246, s[28:31], s67 offen offset:768 sc1
    v_lshrrev_b32 v8, 2, v0
    v_lshlrev_b32 v8, 8, v8
    v_and_b32_e64 v9, 3, v0
    v_lshl_add_u32 v239, v9, 4, v8
    s_mul_i32 s24, s54, 4352
    s_lshr_b32 s56, s3, 1
    s_lshl_b32 s56, s56, 7
    s_add_u32 s24, s24, s56
    s_add_u32 s24, s24, s59
    s_add_u32 s24, s24, 0x60000
    s_add_u32 s57, s57, 0x80000
    s_mul_i32 s46, s54, 790528
    s_mul_i32 s56, s3, 12288
    s_add_u32 s46, s46, s56
    s_mul_i32 s56, s60, 6324224
    s_add_u32 s46, s46, s56
    s_add_u32 s46, s46, 0x1110000
    s_add_u32 s47, s46, 4096
    s_add_u32 s48, s46, 8192
    s_mul_i32 s44, s3, 65792
    s_lshl_b32 s56, s55, 12
    s_add_u32 s44, s44, s56
    v_lshrrev_b32 v8, 3, v0
    v_min_u32 v8, 2, v8
    v_add_u32 v8, s55, v8
    v_add_u32 v8, -1, v8
    v_med3_i32 v8, v8, 0, 15
    v_and_b32_e64 v9, 1, v0
    v_lshl_add_u32 v8, v8, 1, v9
    v_lshlrev_b32_e64 v8, 7, v8
    v_bfe_u32 v9, v0, 1, 2
    v_mul_u32_u24 v9, 4352, v9
    v_add_u32_e64 v251, v8, v9
    s_mul_i32 s25, s53, 17408
    s_add_u32 s25, s25, s59
    s_nop 0
    s_add_u32 s25, s25, 0x80000
    v_accvgpr_write_b32 a0, 0
    v_accvgpr_write_b32 a1, 0
    v_accvgpr_write_b32 a2, 0
    v_accvgpr_write_b32 a3, 0
    v_accvgpr_write_b32 a4, 0
    v_accvgpr_write_b32 a5, 0
    v_accvgpr_write_b32 a6, 0
    v_accvgpr_write_b32 a7, 0
    v_accvgpr_write_b32 a8, 0
    v_accvgpr_write_b32 a9, 0
    v_accvgpr_write_b32 a10, 0
    v_accvgpr_write_b32 a11, 0
    v_accvgpr_write_b32 a12, 0
    v_accvgpr_write_b32 a13, 0
    v_accvgpr_write_b32 a14, 0
    v_accvgpr_write_b32 a15, 0
    v_accvgpr_write_b32 a16, 0
    v_accvgpr_write_b32 a17, 0
    v_accvgpr_write_b32 a18, 0
    v_accvgpr_write_b32 a19, 0
    v_accvgpr_write_b32 a20, 0
    v_accvgpr_write_b32 a21, 0
    v_accvgpr_write_b32 a22, 0
    v_accvgpr_write_b32 a23, 0
    v_accvgpr_write_b32 a24, 0
    v_accvgpr_write_b32 a25, 0
    v_accvgpr_write_b32 a26, 0
    v_accvgpr_write_b32 a27, 0
    v_accvgpr_write_b32 a28, 0
    v_accvgpr_write_b32 a29, 0
    v_accvgpr_write_b32 a30, 0
    v_accvgpr_write_b32 a31, 0
    v_accvgpr_write_b32 a32, 0
    v_accvgpr_write_b32 a33, 0
    v_accvgpr_write_b32 a34, 0
    v_accvgpr_write_b32 a35, 0
    v_accvgpr_write_b32 a36, 0
    v_accvgpr_write_b32 a37, 0
    v_accvgpr_write_b32 a38, 0
    v_accvgpr_write_b32 a39, 0
    v_accvgpr_write_b32 a40, 0
    v_accvgpr_write_b32 a41, 0
    v_accvgpr_write_b32 a42, 0
    v_accvgpr_write_b32 a43, 0
    v_accvgpr_write_b32 a44, 0
    v_accvgpr_write_b32 a45, 0
    v_accvgpr_write_b32 a46, 0
    v_accvgpr_write_b32 a47, 0
    v_accvgpr_write_b32 a48, 0
    v_accvgpr_write_b32 a49, 0
    v_accvgpr_write_b32 a50, 0
    v_accvgpr_write_b32 a51, 0
    v_accvgpr_write_b32 a52, 0
    v_accvgpr_write_b32 a53, 0
    v_accvgpr_write_b32 a54, 0
    v_accvgpr_write_b32 a55, 0
    v_accvgpr_write_b32 a56, 0
    v_accvgpr_write_b32 a57, 0
    v_accvgpr_write_b32 a58, 0
    v_accvgpr_write_b32 a59, 0
    v_accvgpr_write_b32 a60, 0
    v_accvgpr_write_b32 a61, 0
    v_accvgpr_write_b32 a62, 0
    v_accvgpr_write_b32 a63, 0
    v_accvgpr_write_b32 a64, 0
    v_accvgpr_write_b32 a65, 0
    v_accvgpr_write_b32 a66, 0
    v_accvgpr_write_b32 a67, 0
    v_accvgpr_write_b32 a68, 0
    v_accvgpr_write_b32 a69, 0
    v_accvgpr_write_b32 a70, 0
    v_accvgpr_write_b32 a71, 0
    v_accvgpr_write_b32 a72, 0
    v_accvgpr_write_b32 a73, 0
    v_accvgpr_write_b32 a74, 0
    v_accvgpr_write_b32 a75, 0
    v_accvgpr_write_b32 a76, 0
    v_accvgpr_write_b32 a77, 0
    v_accvgpr_write_b32 a78, 0
    v_accvgpr_write_b32 a79, 0
    v_accvgpr_write_b32 a80, 0
    v_accvgpr_write_b32 a81, 0
    v_accvgpr_write_b32 a82, 0
    v_accvgpr_write_b32 a83, 0
    v_accvgpr_write_b32 a84, 0
    v_accvgpr_write_b32 a85, 0
    v_accvgpr_write_b32 a86, 0
    v_accvgpr_write_b32 a87, 0
    v_accvgpr_write_b32 a88, 0
    v_accvgpr_write_b32 a89, 0
    v_accvgpr_write_b32 a90, 0
    v_accvgpr_write_b32 a91, 0
    v_accvgpr_write_b32 a92, 0
    v_accvgpr_write_b32 a93, 0
    v_accvgpr_write_b32 a94, 0
    v_accvgpr_write_b32 a95, 0
    v_accvgpr_write_b32 a96, 0
    v_accvgpr_write_b32 a97, 0
    v_accvgpr_write_b32 a98, 0
    v_accvgpr_write_b32 a99, 0
    buffer_load_dwordx2 v[124:125], v239, s[28:31], s24 offen sc1
    v_accvgpr_write_b32 a100, 0
    v_accvgpr_write_b32 a101, 0
    v_accvgpr_write_b32 a102, 0
    v_accvgpr_write_b32 a103, 0
    v_accvgpr_write_b32 a104, 0
    v_accvgpr_write_b32 a105, 0
    v_accvgpr_write_b32 a106, 0
    v_accvgpr_write_b32 a107, 0
    v_accvgpr_write_b32 a108, 0
    v_accvgpr_write_b32 a109, 0
    v_accvgpr_write_b32 a110, 0
    v_accvgpr_write_b32 a111, 0
    v_accvgpr_write_b32 a112, 0
    v_accvgpr_write_b32 a113, 0
    v_accvgpr_write_b32 a114, 0
    v_accvgpr_write_b32 a115, 0
    v_accvgpr_write_b32 a116, 0
    v_accvgpr_write_b32 a117, 0
    v_accvgpr_write_b32 a118, 0
    v_accvgpr_write_b32 a119, 0
    v_accvgpr_write_b32 a120, 0
    v_accvgpr_write_b32 a121, 0
    v_accvgpr_write_b32 a122, 0
    v_accvgpr_write_b32 a123, 0
    v_accvgpr_write_b32 a124, 0
    v_accvgpr_write_b32 a125, 0
    v_accvgpr_write_b32 a126, 0
    v_accvgpr_write_b32 a127, 0
    v_accvgpr_write_b32 a128, 0
    v_accvgpr_write_b32 a129, 0
    v_accvgpr_write_b32 a130, 0
    v_accvgpr_write_b32 a131, 0
    v_accvgpr_write_b32 a132, 0
    v_accvgpr_write_b32 a133, 0
    v_accvgpr_write_b32 a134, 0
    v_accvgpr_write_b32 a135, 0
    v_accvgpr_write_b32 a136, 0
    v_accvgpr_write_b32 a137, 0
    v_accvgpr_write_b32 a138, 0
    v_accvgpr_write_b32 a139, 0
    v_accvgpr_write_b32 a140, 0
    v_accvgpr_write_b32 a141, 0
    v_accvgpr_write_b32 a142, 0
    v_accvgpr_write_b32 a143, 0
    v_accvgpr_write_b32 a144, 0
    v_accvgpr_write_b32 a145, 0
    v_accvgpr_write_b32 a146, 0
    v_accvgpr_write_b32 a147, 0
    v_accvgpr_write_b32 a148, 0
    v_accvgpr_write_b32 a149, 0
    v_accvgpr_write_b32 a150, 0
    v_accvgpr_write_b32 a151, 0
    v_accvgpr_write_b32 a152, 0
    v_accvgpr_write_b32 a153, 0
    v_accvgpr_write_b32 a154, 0
    v_accvgpr_write_b32 a155, 0
    v_accvgpr_write_b32 a156, 0
    v_accvgpr_write_b32 a157, 0
    v_accvgpr_write_b32 a158, 0
    v_accvgpr_write_b32 a159, 0
    s_waitcnt vmcnt(1)
    s_barrier
    s_cmp_lg_u32 s3, 0
    s_cbranch_scc1 Lnodf
    buffer_store_dwordx2 v[252:253], v249, s[28:31], s57 offen sc1
Lnodf:
    v_accvgpr_write_b32 a160, 0
    v_accvgpr_write_b32 a161, 0
    v_accvgpr_write_b32 a162, 0
    v_accvgpr_write_b32 a163, 0
    v_accvgpr_write_b32 a164, 0
    v_accvgpr_write_b32 a165, 0
    v_accvgpr_write_b32 a166, 0
    v_accvgpr_write_b32 a167, 0
    v_accvgpr_write_b32 a168, 0
    v_accvgpr_write_b32 a169, 0
    v_accvgpr_write_b32 a170, 0
    v_accvgpr_write_b32 a171, 0
    v_accvgpr_write_b32 a172, 0
    v_accvgpr_write_b32 a173, 0
    v_accvgpr_write_b32 a174, 0
    v_accvgpr_write_b32 a175, 0
    v_accvgpr_write_b32 a176, 0
    v_accvgpr_write_b32 a177, 0
    v_accvgpr_write_b32 a178, 0
    v_accvgpr_write_b32 a179, 0
    v_accvgpr_write_b32 a180, 0
    v_accvgpr_write_b32 a181, 0
    v_accvgpr_write_b32 a182, 0
    v_accvgpr_write_b32 a183, 0
    v_accvgpr_write_b32 a184, 0
    v_accvgpr_write_b32 a185, 0
    v_accvgpr_write_b32 a186, 0
    v_accvgpr_write_b32 a187, 0
    v_accvgpr_write_b32 a188, 0
    v_accvgpr_write_b32 a189, 0
    v_accvgpr_write_b32 a190, 0
    v_accvgpr_write_b32 a191, 0
    v_accvgpr_write_b32 a192, 0
    v_accvgpr_write_b32 a193, 0
    v_accvgpr_write_b32 a194, 0
    v_accvgpr_write_b32 a195, 0
    v_accvgpr_write_b32 a196, 0
    v_accvgpr_write_b32 a197, 0
    v_accvgpr_write_b32 a198, 0
    v_accvgpr_write_b32 a199, 0
    v_accvgpr_write_b32 a200, 0
    v_accvgpr_write_b32 a201, 0
    v_accvgpr_write_b32 a202, 0
    v_accvgpr_write_b32 a203, 0
    v_accvgpr_write_b32 a204, 0
    v_accvgpr_write_b32 a205, 0
    v_accvgpr_write_b32 a206, 0
    v_accvgpr_write_b32 a207, 0
    v_accvgpr_write_b32 a208, 0
    v_accvgpr_write_b32 a209, 0
    v_accvgpr_write_b32 a210, 0
    v_accvgpr_write_b32 a211, 0
    v_accvgpr_write_b32 a212, 0
    v_accvgpr_write_b32 a213, 0
    v_accvgpr_write_b32 a214, 0
    v_accvgpr_write_b32 a215, 0
    v_accvgpr_write_b32 a216, 0
    v_accvgpr_write_b32 a217, 0
    v_accvgpr_write_b32 a218, 0
    v_accvgpr_write_b32 a219, 0
    v_accvgpr_write_b32 a220, 0
    v_accvgpr_write_b32 a221, 0
    v_accvgpr_write_b32 a222, 0
    v_accvgpr_write_b32 a223, 0
    v_accvgpr_write_b32 a224, 0
    v_accvgpr_write_b32 a225, 0
    v_accvgpr_write_b32 a226, 0
    v_accvgpr_write_b32 a227, 0
    v_accvgpr_write_b32 a228, 0
    v_accvgpr_write_b32 a229, 0
    v_accvgpr_write_b32 a230, 0
    v_accvgpr_write_b32 a231, 0
    v_accvgpr_write_b32 a232, 0
    v_accvgpr_write_b32 a233, 0
    v_accvgpr_write_b32 a234, 0
    v_accvgpr_write_b32 a235, 0
    v_accvgpr_write_b32 a236, 0
    v_accvgpr_write_b32 a237, 0
    v_accvgpr_write_b32 a238, 0
    v_accvgpr_write_b32 a239, 0
    v_accvgpr_write_b32 a240, 0
    v_accvgpr_write_b32 a241, 0
    v_accvgpr_write_b32 a242, 0
    v_accvgpr_write_b32 a243, 0
    v_accvgpr_write_b32 a244, 0
    v_accvgpr_write_b32 a245, 0
    v_accvgpr_write_b32 a246, 0
    v_accvgpr_write_b32 a247, 0
    v_accvgpr_write_b32 a248, 0
    v_accvgpr_write_b32 a249, 0
    v_accvgpr_write_b32 a250, 0
    v_accvgpr_write_b32 a251, 0
    v_accvgpr_write_b32 a252, 0
    v_accvgpr_write_b32 a253, 0
    v_accvgpr_write_b32 a254, 0
    v_accvgpr_write_b32 a255, 0
    s_mov_b32 s58, 400000
    s_waitcnt vmcnt(1)
    s_cmp_eq_u32 s3, 0
    s_cbranch_scc1 Lu_chk
    s_branch Lu_wait
Lu_poll:
    buffer_load_dwordx2 v[124:125], v239, s[28:31], s24 offen sc1
Lu_wait:
    s_waitcnt vmcnt(0)
Lu_chk:
    v_cmp_ne_u32 vcc, s61, v124
    v_cmp_ne_u32 s[56:57], s61, v125
    s_nop 1
    s_or_b64 s[56:57], s[56:57], vcc
    s_cbranch_scc0 Lu_ok
    s_sub_u32 s58, s58, 1
    s_cmp_lg_u32 s58, 0
    s_cbranch_scc1 Lu_poll
Lu_ok:
    s_cmp_lg_u32 s3, 0
    s_cbranch_scc0 Lw0
    buffer_load_dwordx4 v[104:107], v5, s[28:31], s46 offen offset:0 sc1
    buffer_load_dwordx4 v[108:111], v5, s[28:31], s46 offen offset:1024 sc1
    buffer_load_dwordx4 v[112:115], v5, s[28:31], s46 offen offset:2048 sc1
    buffer_load_dwordx4 v[116:119], v5, s[28:31], s46 offen offset:3072 sc1
    s_add_u32 s46, s46, 49152
    buffer_load_dwordx4 v[120:123], v5, s[28:31], s47 offen offset:0 sc1
    buffer_load_dwordx4 v[124:127], v5, s[28:31], s47 offen offset:1024 sc1
    buffer_load_dwordx4 v[128:131], v5, s[28:31], s47 offen offset:2048 sc1
    buffer_load_dwordx4 v[132:135], v5, s[28:31], s47 offen offset:3072 sc1
    s_add_u32 s47, s47, 49152
    buffer_load_dwordx4 v[136:139], v5, s[28:31], s48 offen offset:0 sc1
    buffer_load_dwordx4 v[140:143], v5, s[28:31], s48 offen offset:1024 sc1
    buffer_load_dwordx4 v[144:147], v5, s[28:31], s48 offen offset:2048 sc1
    buffer_load_dwordx4 v[148:151], v5, s[28:31], s48 offen offset:3072 sc1
    s_add_u32 s48, s48, 49152
    buffer_load_dwordx4 v[152:155], v5, s[28:31], s46 offen offset:0 sc1
    buffer_load_dwordx4 v[156:159], v5, s[28:31], s46 offen offset:1024 sc1
    buffer_load_dwordx4 v[160:163], v5, s[28:31], s46 offen offset:2048 sc1
    buffer_load_dwordx4 v[164:167], v5, s[28:31], s46 offen offset:3072 sc1
    s_add_u32 s46, s46, 49152
    s_branch Ld_ok
Lw0:
    s_nop 0
    buffer_load_dwordx4 v[104:107], v5, s[28:31], s46 offen offset:0 sc1
    buffer_load_dwordx4 v[108:111], v5, s[28:31], s46 offen offset:1024 sc1
    buffer_load_dwordx4 v[112:115], v5, s[28:31], s46 offen offset:2048 sc1
    buffer_load_dwordx4 v[116:119], v5, s[28:31], s46 offen offset:3072 sc1
    s_add_u32 s46, s46, 49152
    buffer_load_dwordx2 v[8:9], v251, s[28:31], s25 offen sc1
    buffer_load_dwordx4 v[120:123], v5, s[28:31], s47 offen offset:0 sc1
    buffer_load_dwordx4 v[124:127], v5, s[28:31], s47 offen offset:1024 sc1
    buffer_load_dwordx4 v[128:131], v5, s[28:31], s47 offen offset:2048 sc1
    buffer_load_dwordx4 v[132:135], v5, s[28:31], s47 offen offset:3072 sc1
    s_add_u32 s47, s47, 49152
    buffer_load_dwordx4 v[136:139], v5, s[28:31], s48 offen offset:0 sc1
    buffer_load_dwordx4 v[140:143], v5, s[28:31], s48 offen offset:1024 sc1
    buffer_load_dwordx4 v[144:147], v5, s[28:31], s48 offen offset:2048 sc1
    buffer_load_dwordx4 v[148:151], v5, s[28:31], s48 offen offset:3072 sc1
    s_add_u32 s48, s48, 49152
    buffer_load_dwordx4 v[152:155], v5, s[28:31], s46 offen offset:0 sc1
    buffer_load_dwordx4 v[156:159], v5, s[28:31], s46 offen offset:1024 sc1
    buffer_load_dwordx4 v[160:163], v5, s[28:31], s46 offen offset:2048 sc1
    buffer_load_dwordx4 v[164:167], v5, s[28:31], s46 offen offset:3072 sc1
    s_add_u32 s46, s46, 49152
    buffer_load_dwordx2 v[10:11], v251, s[28:31], s25 offen sc1
    s_mov_b32 s58, 400000
    s_waitcnt vmcnt(13)
    v_cmp_ne_u32 vcc, s61, v8
    v_cmp_ne_u32 s[56:57], s61, v9
    s_nop 1
    s_or_b64 s[56:57], s[56:57], vcc
    s_cbranch_scc0 Ld_ok
    s_waitcnt vmcnt(0)
    v_cmp_ne_u32 vcc, s61, v10
    v_cmp_ne_u32 s[56:57], s61, v11
    s_nop 1
    s_or_b64 s[56:57], s[56:57], vcc
    s_cbranch_scc0 Ld_ok
Ld_poll:
    buffer_load_dwordx2 v[8:9], v251, s[28:31], s25 offen sc1
Ld_wait:
    s_waitcnt vmcnt(0)
Ld_chk:
    v_cmp_ne_u32 vcc, s61, v8
    v_cmp_ne_u32 s[56:57], s61, v9
    s_nop 1
    s_or_b64 s[56:57], s[56:57], vcc
    s_cbranch_scc0 Ld_ok
    s_sub_u32 s58, s58, 1
    s_cmp_lg_u32 s58, 0
    s_cbranch_scc1 Ld_poll
Ld_ok:
    s_barrier
    s_add_u32 m0, s45, 0
    s_nop 0
    buffer_load_dwordx4 v3, s[32:35], s44 offen offset:0 sc1 lds
    buffer_load_dwordx4 v1, s[32:35], s44 offen offset:1024 sc1 lds
    buffer_load_dwordx4 v1, s[32:35], s44 offen offset:2048 sc1 lds
    buffer_load_dwordx4 v1, s[32:35], s44 offen offset:3072 sc1 lds
    s_add_u32 m0, s45, 4096
    s_nop 0
    buffer_load_dwordx4 v2, s[32:35], s44 offen offset:0 sc1 lds
    buffer_load_dwordx4 v4, s[32:35], s44 offen offset:1024 sc1 lds
    s_add_u32 s44, s44, 0x40400
    s_add_u32 m0, s45, 24576
    s_nop 0
    buffer_load_dwordx4 v3, s[32:35], s44 offen offset:0 sc1 lds
    buffer_load_dwordx4 v1, s[32:35], s44 offen offset:1024 sc1 lds
    buffer_load_dwordx4 v1, s[32:35], s44 offen offset:2048 sc1 lds
    buffer_load_dwordx4 v1, s[32:35], s44 offen offset:3072 sc1 lds
    s_add_u32 m0, s45, 28672
    s_nop 0
    buffer_load_dwordx4 v2, s[32:35], s44 offen offset:0 sc1 lds
    buffer_load_dwordx4 v4, s[32:35], s44 offen offset:1024 sc1 lds
    s_add_u32 s44, s44, 0x40400
    s_xor_b32 s45, s45, 0x10000
    s_mov_b32 s50, 7
    s_add_u32 m0, s45, 0
    s_nop 0
    buffer_load_dwordx4 v3, s[32:35], s44 offen offset:0 sc1 lds
    buffer_load_dwordx4 v1, s[32:35], s44 offen offset:1024 sc1 lds
    s_lshl_b32 s56, s3, 5
    v_and_b32 v8, 31, v0
    v_add_u32_e64 v8, s56, v8
    s_getpc_b64 s[56:57]
Lpc2:
    s_add_u32 s56, s56, Ltail-Lpc2
    s_addc_u32 s57, s57, 0
    v_lshlrev_b32 v234, 7, v8
    v_min_u32 v234, Lcode_end-Ltail-4, v234
    v_mov_b32 v235, s57
    v_add_co_u32 v234, vcc, s56, v234
    s_nop 1
    v_addc_co_u32 v235, vcc, 0, v235, vcc
    s_waitcnt vmcnt(8)
    s_barrier
    ds_read_b128 v[8:11], v6 offset:0
    ds_read_b128 v[88:91], v7 offset:0
    ds_read_b128 v[12:15], v6 offset:512
    ds_read_b128 v[92:95], v7 offset:512
    ds_read_b128 v[16:19], v254 offset:0
    ds_read_b128 v[96:99], v255 offset:0
    ds_read_b128 v[20:23], v254 offset:512
    ds_read_b128 v[100:103], v255 offset:512
    ds_read_b128 v[24:27], v6 offset:256
    ds_read_b128 v[72:75], v7 offset:256
    ds_read_b128 v[28:31], v6 offset:768
    ds_read_b128 v[76:79], v7 offset:768
    buffer_load_dwordx4 v1, s[32:35], s44 offen offset:2048 sc1 lds
    ds_read_b128 v[32:35], v254 offset:256
    ds_read_b128 v[80:83], v255 offset:256
    ds_read_b128 v[36:39], v254 offset:768
    ds_read_b128 v[84:87], v255 offset:768
    s_waitcnt lgkmcnt(14)
    buffer_load_dwordx4 v1, s[32:35], s44 offen offset:3072 sc1 lds
    v_pk_fma_f16 v8, v88, s49, v8
    v_pk_fma_f16 v9, v89, s49, v9
    v_pk_fma_f16 v10, v90, s49, v10
    v_pk_fma_f16 v11, v91, s49, v11
    s_waitcnt lgkmcnt(12)
    v_pk_fma_f16 v12, v92, s49, v12
    s_add_u32 m0, s45, 4096
    s_nop 0
    buffer_load_dwordx4 v2, s[32:35], s44 offen offset:0 sc1 lds
    v_pk_fma_f16 v13, v93, s49, v13
    v_pk_fma_f16 v14, v94, s49, v14
    v_pk_fma_f16 v15, v95, s49, v15
    s_waitcnt lgkmcnt(10)
    v_pk_fma_f16 v16, v96, s49, v16
    buffer_load_dwordx4 v4, s[32:35], s44 offen offset:1024 sc1 lds
    s_add_u32 s44, s44, 0x40400
    v_pk_fma_f16 v17, v97, s49, v17
    v_pk_fma_f16 v18, v98, s49, v18
    v_pk_fma_f16 v19, v99, s49, v19
    s_waitcnt lgkmcnt(8)
    v_pk_fma_f16 v20, v100, s49, v20
    v_pk_fma_f16 v21, v101, s49, v21
    buffer_load_dwordx4 v[168:171], v5, s[28:31], s47 offen offset:0 sc1
    v_pk_fma_f16 v22, v102, s49, v22
    v_pk_fma_f16 v23, v103, s49, v23
    s_waitcnt lgkmcnt(6)
    v_pk_fma_f16 v24, v72, s49, v24
    v_pk_fma_f16 v25, v73, s49, v25
    buffer_load_dwordx4 v[172:175], v5, s[28:31], s47 offen offset:1024 sc1
    v_pk_fma_f16 v26, v74, s49, v26
    v_pk_fma_f16 v27, v75, s49, v27
    s_waitcnt lgkmcnt(4)
    v_pk_fma_f16 v28, v76, s49, v28
    v_pk_fma_f16 v29, v77, s49, v29
    v_pk_fma_f16 v30, v78, s49, v30
    buffer_load_dwordx4 v[176:179], v5, s[28:31], s47 offen offset:2048 sc1
    v_pk_fma_f16 v31, v79, s49, v31
    s_waitcnt lgkmcnt(2)
    v_pk_fma_f16 v32, v80, s49, v32
    v_pk_fma_f16 v33, v81, s49, v33
    v_pk_fma_f16 v34, v82, s49, v34
    buffer_load_dwordx4 v[180:183], v5, s[28:31], s47 offen offset:3072 sc1
    s_add_u32 s47, s47, 49152
    v_pk_fma_f16 v35, v83, s49, v35
    s_waitcnt lgkmcnt(0)
    v_pk_fma_f16 v36, v84, s49, v36
    v_pk_fma_f16 v37, v85, s49, v37
    v_pk_fma_f16 v38, v86, s49, v38
    v_pk_fma_f16 v39, v87, s49, v39
    s_waitcnt vmcnt(10)
    s_mov_b32 s101, 49152
    s_sub_u32 s47, s47, 49152
    s_cmp_eq_u32 s60, 0
    s_cbranch_scc1 Lgo
    s_cmp_lg_u32 s2, 2
    s_cbranch_scc1 Lgo
    s_cmp_lg_u32 s3, 0
    s_cbranch_scc1 Lgo
    buffer_store_dword v252, v249, s[28:31], 0 offen offset:0 sc1
Lgo:
.p2align 6
Lloop:
    s_waitcnt vmcnt(22)
    s_barrier
    v_mfma_f32_16x16x32_f16 a[0:3], v[104:107], v[8:11], a[0:3]
    ds_read_b128 v[40:43], v6 offset:24576
    ds_read_b128 v[88:91], v7 offset:24576
    v_pk_add_f16 v72, v8, v24
    v_mfma_f32_16x16x32_f16 a[4:7], v[104:107], v[12:15], a[4:7]
    buffer_load_dwordx4 v[184:187], v5, s[28:31], s48 offen offset:0 sc1
    v_mfma_f32_16x16x32_f16 a[8:11], v[104:107], v[16:19], a[8:11]
    ds_read_b128 v[44:47], v6 offset:25088
    ds_read_b128 v[92:95], v7 offset:25088
    v_pk_add_f16 v73, v9, v25
    v_mfma_f32_16x16x32_f16 a[12:15], v[104:107], v[20:23], a[12:15]
    ds_read_b128 v[56:59], v6 offset:24832
    ds_read_b128 v[96:99], v7 offset:24832
    v_mfma_f32_16x16x32_f16 a[28:31], v[108:111], v[20:23], a[28:31]
    buffer_load_dwordx4 v[188:191], v5, s[28:31], s48 offen offset:1024 sc1
    v_mfma_f32_16x16x32_f16 a[24:27], v[108:111], v[16:19], a[24:27]
    ds_read_b128 v[60:63], v6 offset:25344
    ds_read_b128 v[100:103], v7 offset:25344
    v_pk_add_f16 v74, v10, v26
    v_mfma_f32_16x16x32_f16 a[20:23], v[108:111], v[12:15], a[20:23]
    ds_read_b128 v[48:51], v255 offset:24576
    v_pk_add_f16 v75, v11, v27
    v_pk_add_f16 v76, v12, v28
    v_mfma_f32_16x16x32_f16 a[16:19], v[108:111], v[8:11], a[16:19]
    ds_read_b128 v[52:55], v255 offset:25088
    v_pk_add_f16 v77, v13, v29
    v_mfma_f32_16x16x32_f16 a[32:35], v[112:115], v[8:11], a[32:35]
    buffer_load_dwordx4 v[192:195], v5, s[28:31], s48 offen offset:2048 sc1
    v_mfma_f32_16x16x32_f16 a[36:39], v[112:115], v[12:15], a[36:39]
    ds_read_b128 v[64:67], v255 offset:24832
    v_pk_add_f16 v78, v14, v30
    v_pk_add_f16 v79, v15, v31
    v_mfma_f32_16x16x32_f16 a[40:43], v[112:115], v[16:19], a[40:43]
    ds_read_b128 v[68:71], v255 offset:25344
    v_pk_add_f16 v80, v16, v32
    v_mfma_f32_16x16x32_f16 a[44:47], v[112:115], v[20:23], a[44:47]
    buffer_load_dwordx4 v[196:199], v5, s[28:31], s48 offen offset:3072 sc1
    v_mfma_f32_16x16x32_f16 a[60:63], v[116:119], v[20:23], a[60:63]
    s_add_u32 m0, s45, 24576
    v_pk_add_f16 v81, v17, v33
    v_pk_add_f16 v82, v18, v34
    v_mfma_f32_16x16x32_f16 a[56:59], v[116:119], v[16:19], a[56:59]
    s_add_u32 s48, s48, s101
    v_pk_add_f16 v83, v19, v35
    v_pk_add_f16 v84, v20, v36
    v_pk_add_f16 v85, v21, v37
    v_mfma_f32_16x16x32_f16 a[52:55], v[116:119], v[12:15], a[52:55]
    s_waitcnt vmcnt(22)
    v_pk_add_f16 v86, v22, v38
    v_pk_add_f16 v87, v23, v39
    v_mfma_f32_16x16x32_f16 a[48:51], v[116:119], v[8:11], a[48:51]
    buffer_load_dwordx4 v3, s[32:35], s44 offen offset:0 sc1 lds
    v_mfma_f32_16x16x32_f16 a[64:67], v[120:123], v[72:75], a[64:67]
    v_pk_add_f16 v8, v8, v24 neg_lo:[0,1] neg_hi:[0,1]
    v_pk_add_f16 v9, v9, v25 neg_lo:[0,1] neg_hi:[0,1]
    v_pk_add_f16 v10, v10, v26 neg_lo:[0,1] neg_hi:[0,1]
    v_mfma_f32_16x16x32_f16 a[68:71], v[120:123], v[76:79], a[68:71]
    v_pk_add_f16 v11, v11, v27 neg_lo:[0,1] neg_hi:[0,1]
    v_pk_add_f16 v12, v12, v28 neg_lo:[0,1] neg_hi:[0,1]
    v_pk_add_f16 v13, v13, v29 neg_lo:[0,1] neg_hi:[0,1]
    v_mfma_f32_16x16x32_f16 a[72:75], v[120:123], v[80:83], a[72:75]
    buffer_load_dwordx4 v1, s[32:35], s44 offen offset:1024 sc1 lds
    v_mfma_f32_16x16x32_f16 a[76:79], v[120:123], v[84:87], a[76:79]
    v_pk_add_f16 v14, v14, v30 neg_lo:[0,1] neg_hi:[0,1]
    v_pk_add_f16 v120, v120, v104 neg_lo:[0,1] neg_hi:[0,1]
    v_pk_add_f16 v121, v121, v105 neg_lo:[0,1] neg_hi:[0,1]
    v_mfma_f32_16x16x32_f16 a[92:95], v[124:127], v[84:87], a[92:95]
    v_pk_add_f16 v122, v122, v106 neg_lo:[0,1] neg_hi:[0,1]
    v_pk_add_f16 v123, v123, v107 neg_lo:[0,1] neg_hi:[0,1]
    v_mfma_f32_16x16x32_f16 a[88:91], v[124:127], v[80:83], a[88:91]
    v_pk_add_f16 v15, v15, v31 neg_lo:[0,1] neg_hi:[0,1]
    v_pk_add_f16 v16, v16, v32 neg_lo:[0,1] neg_hi:[0,1]
    v_xor_b32 v6, 0x10000, v6
    v_mfma_f32_16x16x32_f16 a[84:87], v[124:127], v[76:79], a[84:87]
    buffer_load_dwordx4 v1, s[32:35], s44 offen offset:2048 sc1 lds
    v_mfma_f32_16x16x32_f16 a[80:83], v[124:127], v[72:75], a[80:83]
    v_pk_add_f16 v17, v17, v33 neg_lo:[0,1] neg_hi:[0,1]
    v_pk_add_f16 v124, v124, v108 neg_lo:[0,1] neg_hi:[0,1]
    v_pk_add_f16 v125, v125, v109 neg_lo:[0,1] neg_hi:[0,1]
    v_mfma_f32_16x16x32_f16 a[96:99], v[128:131], v[72:75], a[96:99]
    v_pk_add_f16 v126, v126, v110 neg_lo:[0,1] neg_hi:[0,1]
    v_pk_add_f16 v127, v127, v111 neg_lo:[0,1] neg_hi:[0,1]
    v_mfma_f32_16x16x32_f16 a[100:103], v[128:131], v[76:79], a[100:103]
    buffer_load_dwordx4 v1, s[32:35], s44 offen offset:3072 sc1 lds
    v_mfma_f32_16x16x32_f16 a[104:107], v[128:131], v[80:83], a[104:107]
    v_pk_add_f16 v18, v18, v34 neg_lo:[0,1] neg_hi:[0,1]
    v_pk_add_f16 v19, v19, v35 neg_lo:[0,1] neg_hi:[0,1]
    v_xor_b32 v7, 0x10000, v7
    v_mfma_f32_16x16x32_f16 a[108:111], v[128:131], v[84:87], a[108:111]
    s_add_u32 m0, s45, 28672
    v_pk_add_f16 v20, v20, v36 neg_lo:[0,1] neg_hi:[0,1]
    v_pk_add_f16 v128, v128, v112 neg_lo:[0,1] neg_hi:[0,1]
    v_pk_add_f16 v129, v129, v113 neg_lo:[0,1] neg_hi:[0,1]
    v_mfma_f32_16x16x32_f16 a[124:127], v[132:135], v[84:87], a[124:127]
    v_pk_add_f16 v130, v130, v114 neg_lo:[0,1] neg_hi:[0,1]
    v_pk_add_f16 v131, v131, v115 neg_lo:[0,1] neg_hi:[0,1]
    v_mfma_f32_16x16x32_f16 a[120:123], v[132:135], v[80:83], a[120:123]
    buffer_load_dwordx4 v2, s[32:35], s44 offen offset:0 sc1 lds
    v_mfma_f32_16x16x32_f16 a[116:119], v[132:135], v[76:79], a[116:119]
    s_add_u32 s47, s47, s101
    v_pk_add_f16 v21, v21, v37 neg_lo:[0,1] neg_hi:[0,1]
    v_pk_add_f16 v22, v22, v38 neg_lo:[0,1] neg_hi:[0,1]
    v_pk_add_f16 v23, v23, v39 neg_lo:[0,1] neg_hi:[0,1]
    v_mfma_f32_16x16x32_f16 a[112:115], v[132:135], v[72:75], a[112:115]
    s_waitcnt vmcnt(23) lgkmcnt(0)
    v_pk_add_f16 v132, v132, v116 neg_lo:[0,1] neg_hi:[0,1]
    v_pk_add_f16 v133, v133, v117 neg_lo:[0,1] neg_hi:[0,1]
    v_mfma_f32_16x16x32_f16 a[128:131], v[136:139], v[8:11], a[128:131]
    buffer_load_dwordx4 v4, s[32:35], s44 offen offset:1024 sc1 lds
    v_mfma_f32_16x16x32_f16 a[132:135], v[136:139], v[12:15], a[132:135]
    v_pk_add_f16 v134, v134, v118 neg_lo:[0,1] neg_hi:[0,1]
    v_pk_fma_f16 v40, v88, s49, v40
    v_pk_fma_f16 v41, v89, s49, v41
    v_mfma_f32_16x16x32_f16 a[136:139], v[136:139], v[16:19], a[136:139]
    v_pk_add_f16 v135, v135, v119 neg_lo:[0,1] neg_hi:[0,1]
    v_pk_fma_f16 v42, v90, s49, v42
    v_pk_fma_f16 v43, v91, s49, v43
    v_mfma_f32_16x16x32_f16 a[140:143], v[136:139], v[20:23], a[140:143]
    v_pk_add_f16 v136, v120, v136
    v_pk_fma_f16 v44, v92, s49, v44
    v_pk_fma_f16 v45, v93, s49, v45
    v_mfma_f32_16x16x32_f16 a[156:159], v[140:143], v[20:23], a[156:159]
    buffer_load_dwordx4 v[104:107], v5, s[28:31], s46 offen offset:0 sc1
    v_mfma_f32_16x16x32_f16 a[152:155], v[140:143], v[16:19], a[152:155]
    v_pk_add_f16 v137, v121, v137
    v_pk_fma_f16 v46, v94, s49, v46
    v_pk_fma_f16 v47, v95, s49, v47
    v_mfma_f32_16x16x32_f16 a[148:151], v[140:143], v[12:15], a[148:151]
    v_pk_fma_f16 v56, v96, s49, v56
    v_pk_fma_f16 v57, v97, s49, v57
    v_pk_fma_f16 v58, v98, s49, v58
    v_mfma_f32_16x16x32_f16 a[144:147], v[140:143], v[8:11], a[144:147]
    buffer_load_dwordx4 v[108:111], v5, s[28:31], s46 offen offset:1024 sc1
    v_mfma_f32_16x16x32_f16 a[160:163], v[144:147], v[8:11], a[160:163]
    s_add_u32 s44, s44, 0x40400
    v_pk_add_f16 v138, v122, v138
    v_pk_add_f16 v139, v123, v139
    v_mfma_f32_16x16x32_f16 a[164:167], v[144:147], v[12:15], a[164:167]
    s_xor_b32 s45, s45, 0x10000
    v_pk_fma_f16 v59, v99, s49, v59
    v_pk_fma_f16 v60, v100, s49, v60
    v_xor_b32 v255, 0x10000, v255
    v_mfma_f32_16x16x32_f16 a[168:171], v[144:147], v[16:19], a[168:171]
    v_pk_add_f16 v140, v124, v140
    v_pk_add_f16 v141, v125, v141
    v_mfma_f32_16x16x32_f16 a[172:175], v[144:147], v[20:23], a[172:175]
    buffer_load_dwordx4 v[112:115], v5, s[28:31], s46 offen offset:2048 sc1
    v_mfma_f32_16x16x32_f16 a[188:191], v[148:151], v[20:23], a[188:191]
    v_pk_fma_f16 v61, v101, s49, v61
    v_pk_fma_f16 v62, v102, s49, v62
    v_pk_fma_f16 v63, v103, s49, v63
    v_mfma_f32_16x16x32_f16 a[184:187], v[148:151], v[16:19], a[184:187]
    v_pk_add_f16 v142, v126, v142
    v_pk_add_f16 v143, v127, v143
    v_mfma_f32_16x16x32_f16 a[180:183], v[148:151], v[12:15], a[180:183]
    buffer_load_dwordx4 v[116:119], v5, s[28:31], s46 offen offset:3072 sc1
    v_mfma_f32_16x16x32_f16 a[176:179], v[148:151], v[8:11], a[176:179]
    s_mov_b64 exec, s[4:5]
    ds_read_b128 v[88:91], v254 offset:24576
    ds_read_b128 v[92:95], v254 offset:25088
    s_mov_b64 exec, -1
    v_mfma_f32_16x16x32_f16 a[192:195], v[136:139], v[24:27], a[192:195]
    s_mov_b64 exec, s[4:5]
    ds_read_b128 v[96:99], v254 offset:24832
    ds_read_b128 v[100:103], v254 offset:25344
    s_mov_b64 exec, -1
    v_mfma_f32_16x16x32_f16 a[196:199], v[136:139], v[28:31], a[196:199]
    v_pk_add_f16 v144, v128, v144
    v_pk_add_f16 v145, v129, v145
    v_pk_add_f16 v146, v130, v146
    v_mfma_f32_16x16x32_f16 a[200:203], v[136:139], v[32:35], a[200:203]
    buffer_load_dwordx4 v[120:123], v5, s[28:31], s47 offen offset:0 sc1
    v_mfma_f32_16x16x32_f16 a[204:207], v[136:139], v[36:39], a[204:207]
    v_pk_add_f16 v147, v131, v147
    v_pk_add_f16 v148, v132, v148
    v_pk_add_f16 v149, v133, v149
    v_mfma_f32_16x16x32_f16 a[220:223], v[140:143], v[36:39], a[220:223]
    s_add_u32 s46, s46, s101
    v_pk_add_f16 v150, v134, v150
    v_pk_add_f16 v151, v135, v151
    v_mfma_f32_16x16x32_f16 a[216:219], v[140:143], v[32:35], a[216:219]
    buffer_load_dwordx4 v[124:127], v5, s[28:31], s47 offen offset:1024 sc1
    v_mfma_f32_16x16x32_f16 a[212:215], v[140:143], v[28:31], a[212:215]
    s_waitcnt lgkmcnt(0)
    v_pk_fma_f16 v48, v48, s49, v88
    v_pk_fma_f16 v49, v49, s49, v89
    v_mfma_f32_16x16x32_f16 a[208:211], v[140:143], v[24:27], a[208:211]
    v_pk_fma_f16 v50, v50, s49, v90
    v_pk_fma_f16 v51, v51, s49, v91
    v_pk_fma_f16 v52, v52, s49, v92
    v_mfma_f32_16x16x32_f16 a[224:227], v[144:147], v[24:27], a[224:227]
    v_pk_fma_f16 v53, v53, s49, v93
    v_pk_fma_f16 v54, v54, s49, v94
    v_xor_b32 v254, 0x10000, v254
    v_mfma_f32_16x16x32_f16 a[228:231], v[144:147], v[28:31], a[228:231]
    buffer_load_dwordx4 v[128:131], v5, s[28:31], s47 offen offset:2048 sc1
    v_mfma_f32_16x16x32_f16 a[232:235], v[144:147], v[32:35], a[232:235]
    v_pk_fma_f16 v55, v55, s49, v95
    v_pk_fma_f16 v64, v64, s49, v96
    v_pk_fma_f16 v65, v65, s49, v97
    v_mfma_f32_16x16x32_f16 a[236:239], v[144:147], v[36:39], a[236:239]
    v_pk_fma_f16 v66, v66, s49, v98
    v_pk_fma_f16 v67, v67, s49, v99
    v_mfma_f32_16x16x32_f16 a[252:255], v[148:151], v[36:39], a[252:255]
    buffer_load_dwordx4 v[132:135], v5, s[28:31], s47 offen offset:3072 sc1
    v_mfma_f32_16x16x32_f16 a[248:251], v[148:151], v[32:35], a[248:251]
    v_pk_fma_f16 v68, v68, s49, v100
    v_pk_fma_f16 v69, v69, s49, v101
    v_mfma_f32_16x16x32_f16 a[244:247], v[148:151], v[28:31], a[244:247]
    v_pk_fma_f16 v70, v70, s49, v102
    v_pk_fma_f16 v71, v71, s49, v103
    v_mfma_f32_16x16x32_f16 a[240:243], v[148:151], v[24:27], a[240:243]
    s_waitcnt vmcnt(22)
    s_barrier
    v_mfma_f32_16x16x32_f16 a[0:3], v[152:155], v[40:43], a[0:3]
    ds_read_b128 v[8:11], v6 offset:0
    ds_read_b128 v[88:91], v7 offset:0
    v_pk_add_f16 v72, v40, v56
    v_mfma_f32_16x16x32_f16 a[4:7], v[152:155], v[44:47], a[4:7]
    buffer_load_dwordx4 v[136:139], v5, s[28:31], s48 offen offset:0 sc1
    v_mfma_f32_16x16x32_f16 a[8:11], v[152:155], v[48:51], a[8:11]
    ds_read_b128 v[12:15], v6 offset:512
    ds_read_b128 v[92:95], v7 offset:512
    v_pk_add_f16 v73, v41, v57
    v_mfma_f32_16x16x32_f16 a[12:15], v[152:155], v[52:55], a[12:15]
    ds_read_b128 v[24:27], v6 offset:256
    ds_read_b128 v[96:99], v7 offset:256
    v_mfma_f32_16x16x32_f16 a[28:31], v[156:159], v[52:55], a[28:31]
    buffer_load_dwordx4 v[140:143], v5, s[28:31], s48 offen offset:1024 sc1
    v_mfma_f32_16x16x32_f16 a[24:27], v[156:159], v[48:51], a[24:27]
    ds_read_b128 v[28:31], v6 offset:768
    ds_read_b128 v[100:103], v7 offset:768
    v_pk_add_f16 v74, v42, v58
    v_mfma_f32_16x16x32_f16 a[20:23], v[156:159], v[44:47], a[20:23]
    ds_read_b128 v[16:19], v255 offset:0
    v_pk_add_f16 v75, v43, v59
    v_pk_add_f16 v76, v44, v60
    v_mfma_f32_16x16x32_f16 a[16:19], v[156:159], v[40:43], a[16:19]
    ds_read_b128 v[20:23], v255 offset:512
    v_pk_add_f16 v77, v45, v61
    v_mfma_f32_16x16x32_f16 a[32:35], v[160:163], v[40:43], a[32:35]
    buffer_load_dwordx4 v[144:147], v5, s[28:31], s48 offen offset:2048 sc1
    v_mfma_f32_16x16x32_f16 a[36:39], v[160:163], v[44:47], a[36:39]
    ds_read_b128 v[32:35], v255 offset:256
    v_pk_add_f16 v78, v46, v62
    v_pk_add_f16 v79, v47, v63
    v_mfma_f32_16x16x32_f16 a[40:43], v[160:163], v[48:51], a[40:43]
    ds_read_b128 v[36:39], v255 offset:768
    v_pk_add_f16 v80, v48, v64
    v_mfma_f32_16x16x32_f16 a[44:47], v[160:163], v[52:55], a[44:47]
    buffer_load_dwordx4 v[148:151], v5, s[28:31], s48 offen offset:3072 sc1
    v_mfma_f32_16x16x32_f16 a[60:63], v[164:167], v[52:55], a[60:63]
    s_add_u32 m0, s45, 0
    v_pk_add_f16 v81, v49, v65
    v_pk_add_f16 v82, v50, v66
    v_mfma_f32_16x16x32_f16 a[56:59], v[164:167], v[48:51], a[56:59]
    s_add_u32 s48, s48, s101
    v_pk_add_f16 v83, v51, v67
    v_pk_add_f16 v84, v52, v68
    v_pk_add_f16 v85, v53, v69
    v_mfma_f32_16x16x32_f16 a[52:55], v[164:167], v[44:47], a[52:55]
    s_waitcnt vmcnt(22)
    s_nop 0
    v_pk_add_f16 v86, v54, v70
    v_pk_add_f16 v87, v55, v71
    v_mfma_f32_16x16x32_f16 a[48:51], v[164:167], v[40:43], a[48:51]
    buffer_load_dwordx4 v3, s[32:35], s44 offen offset:0 sc1 lds
    v_mfma_f32_16x16x32_f16 a[64:67], v[168:171], v[72:75], a[64:67]
    v_pk_add_f16 v40, v40, v56 neg_lo:[0,1] neg_hi:[0,1]
    v_pk_add_f16 v41, v41, v57 neg_lo:[0,1] neg_hi:[0,1]
    v_pk_add_f16 v42, v42, v58 neg_lo:[0,1] neg_hi:[0,1]
    v_mfma_f32_16x16x32_f16 a[68:71], v[168:171], v[76:79], a[68:71]
    v_pk_add_f16 v43, v43, v59 neg_lo:[0,1] neg_hi:[0,1]
    v_pk_add_f16 v44, v44, v60 neg_lo:[0,1] neg_hi:[0,1]
    v_pk_add_f16 v45, v45, v61 neg_lo:[0,1] neg_hi:[0,1]
    v_mfma_f32_16x16x32_f16 a[72:75], v[168:171], v[80:83], a[72:75]
    buffer_load_dwordx4 v1, s[32:35], s44 offen offset:1024 sc1 lds
    v_mfma_f32_16x16x32_f16 a[76:79], v[168:171], v[84:87], a[76:79]
    v_pk_add_f16 v46, v46, v62 neg_lo:[0,1] neg_hi:[0,1]
    v_pk_add_f16 v168, v168, v152 neg_lo:[0,1] neg_hi:[0,1]
    v_pk_add_f16 v169, v169, v153 neg_lo:[0,1] neg_hi:[0,1]
    v_mfma_f32_16x16x32_f16 a[92:95], v[172:175], v[84:87], a[92:95]
    v_pk_add_f16 v170, v170, v154 neg_lo:[0,1] neg_hi:[0,1]
    v_pk_add_f16 v171, v171, v155 neg_lo:[0,1] neg_hi:[0,1]
    v_mfma_f32_16x16x32_f16 a[88:91], v[172:175], v[80:83], a[88:91]
    v_pk_add_f16 v47, v47, v63 neg_lo:[0,1] neg_hi:[0,1]
    v_pk_add_f16 v48, v48, v64 neg_lo:[0,1] neg_hi:[0,1]
    v_mfma_f32_16x16x32_f16 a[84:87], v[172:175], v[76:79], a[84:87]
    buffer_load_dwordx4 v1, s[32:35], s44 offen offset:2048 sc1 lds
    v_mfma_f32_16x16x32_f16 a[80:83], v[172:175], v[72:75], a[80:83]
    v_pk_add_f16 v49, v49, v65 neg_lo:[0,1] neg_hi:[0,1]
    v_pk_add_f16 v172, v172, v156 neg_lo:[0,1] neg_hi:[0,1]
    v_pk_add_f16 v173, v173, v157 neg_lo:[0,1] neg_hi:[0,1]
    v_mfma_f32_16x16x32_f16 a[96:99], v[176:179], v[72:75], a[96:99]
    v_pk_add_f16 v174, v174, v158 neg_lo:[0,1] neg_hi:[0,1]
    v_pk_add_f16 v175, v175, v159 neg_lo:[0,1] neg_hi:[0,1]
    v_mfma_f32_16x16x32_f16 a[100:103], v[176:179], v[76:79], a[100:103]
    buffer_load_dwordx4 v1, s[32:35], s44 offen offset:3072 sc1 lds
    v_mfma_f32_16x16x32_f16 a[104:107], v[176:179], v[80:83], a[104:107]
    v_pk_add_f16 v50, v50, v66 neg_lo:[0,1] neg_hi:[0,1]
    v_pk_add_f16 v51, v51, v67 neg_lo:[0,1] neg_hi:[0,1]
    v_mfma_f32_16x16x32_f16 a[108:111], v[176:179], v[84:87], a[108:111]
    s_add_u32 m0, s45, 4096
    v_pk_add_f16 v52, v52, v68 neg_lo:[0,1] neg_hi:[0,1]
    v_pk_add_f16 v176, v176, v160 neg_lo:[0,1] neg_hi:[0,1]
    v_pk_add_f16 v177, v177, v161 neg_lo:[0,1] neg_hi:[0,1]
    v_mfma_f32_16x16x32_f16 a[124:127], v[180:183], v[84:87], a[124:127]
    v_pk_add_f16 v178, v178, v162 neg_lo:[0,1] neg_hi:[0,1]
    v_pk_add_f16 v179, v179, v163 neg_lo:[0,1] neg_hi:[0,1]
    v_mfma_f32_16x16x32_f16 a[120:123], v[180:183], v[80:83], a[120:123]
    buffer_load_dwordx4 v2, s[32:35], s44 offen offset:0 sc1 lds
    v_mfma_f32_16x16x32_f16 a[116:119], v[180:183], v[76:79], a[116:119]
    s_add_u32 s47, s47, s101
    v_pk_add_f16 v53, v53, v69 neg_lo:[0,1] neg_hi:[0,1]
    v_pk_add_f16 v54, v54, v70 neg_lo:[0,1] neg_hi:[0,1]
    v_pk_add_f16 v55, v55, v71 neg_lo:[0,1] neg_hi:[0,1]
    v_mfma_f32_16x16x32_f16 a[112:115], v[180:183], v[72:75], a[112:115]
    s_waitcnt vmcnt(23) lgkmcnt(0)
    v_pk_add_f16 v180, v180, v164 neg_lo:[0,1] neg_hi:[0,1]
    v_pk_add_f16 v181, v181, v165 neg_lo:[0,1] neg_hi:[0,1]
    v_mfma_f32_16x16x32_f16 a[128:131], v[184:187], v[40:43], a[128:131]
    buffer_load_dwordx4 v4, s[32:35], s44 offen offset:1024 sc1 lds
    v_mfma_f32_16x16x32_f16 a[132:135], v[184:187], v[44:47], a[132:135]
    v_pk_add_f16 v182, v182, v166 neg_lo:[0,1] neg_hi:[0,1]
    v_pk_fma_f16 v8, v88, s49, v8
    v_pk_fma_f16 v9, v89, s49, v9
    v_mfma_f32_16x16x32_f16 a[136:139], v[184:187], v[48:51], a[136:139]
    v_pk_add_f16 v183, v183, v167 neg_lo:[0,1] neg_hi:[0,1]
    v_pk_fma_f16 v10, v90, s49, v10
    v_pk_fma_f16 v11, v91, s49, v11
    v_mfma_f32_16x16x32_f16 a[140:143], v[184:187], v[52:55], a[140:143]
    v_pk_add_f16 v184, v168, v184
    v_pk_fma_f16 v12, v92, s49, v12
    v_pk_fma_f16 v13, v93, s49, v13
    v_mfma_f32_16x16x32_f16 a[156:159], v[188:191], v[52:55], a[156:159]
    buffer_load_dwordx4 v[152:155], v5, s[28:31], s46 offen offset:0 sc1
    v_mfma_f32_16x16x32_f16 a[152:155], v[188:191], v[48:51], a[152:155]
    v_pk_add_f16 v185, v169, v185
    v_pk_fma_f16 v14, v94, s49, v14
    v_pk_fma_f16 v15, v95, s49, v15
    v_mfma_f32_16x16x32_f16 a[148:151], v[188:191], v[44:47], a[148:151]
    v_pk_fma_f16 v24, v96, s49, v24
    v_pk_fma_f16 v25, v97, s49, v25
    v_pk_fma_f16 v26, v98, s49, v26
    v_mfma_f32_16x16x32_f16 a[144:147], v[188:191], v[40:43], a[144:147]
    buffer_load_dwordx4 v[156:159], v5, s[28:31], s46 offen offset:1024 sc1
    v_mfma_f32_16x16x32_f16 a[160:163], v[192:195], v[40:43], a[160:163]
    s_add_u32 s44, s44, 0x40400
    v_pk_add_f16 v186, v170, v186
    v_pk_add_f16 v187, v171, v187
    v_mfma_f32_16x16x32_f16 a[164:167], v[192:195], v[44:47], a[164:167]
    v_pk_fma_f16 v27, v99, s49, v27
    v_pk_fma_f16 v28, v100, s49, v28
    v_mfma_f32_16x16x32_f16 a[168:171], v[192:195], v[48:51], a[168:171]
    v_pk_add_f16 v188, v172, v188
    v_pk_add_f16 v189, v173, v189
    v_mfma_f32_16x16x32_f16 a[172:175], v[192:195], v[52:55], a[172:175]
    buffer_load_dwordx4 v[160:163], v5, s[28:31], s46 offen offset:2048 sc1
    v_mfma_f32_16x16x32_f16 a[188:191], v[196:199], v[52:55], a[188:191]
    v_pk_fma_f16 v29, v101, s49, v29
    v_pk_fma_f16 v30, v102, s49, v30
    v_pk_fma_f16 v31, v103, s49, v31
    v_mfma_f32_16x16x32_f16 a[184:187], v[196:199], v[48:51], a[184:187]
    v_pk_add_f16 v190, v174, v190
    v_pk_add_f16 v191, v175, v191
    v_mfma_f32_16x16x32_f16 a[180:183], v[196:199], v[44:47], a[180:183]
    buffer_load_dwordx4 v[164:167], v5, s[28:31], s46 offen offset:3072 sc1
    v_mfma_f32_16x16x32_f16 a[176:179], v[196:199], v[40:43], a[176:179]
    s_mov_b64 exec, s[4:5]
    ds_read_b128 v[88:91], v254 offset:0
    ds_read_b128 v[92:95], v254 offset:512
    s_mov_b64 exec, -1
    v_mfma_f32_16x16x32_f16 a[192:195], v[184:187], v[56:59], a[192:195]
    s_mov_b64 exec, s[4:5]
    ds_read_b128 v[96:99], v254 offset:256
    ds_read_b128 v[100:103], v254 offset:768
    s_mov_b64 exec, -1
    v_mfma_f32_16x16x32_f16 a[196:199], v[184:187], v[60:63], a[196:199]
    v_pk_add_f16 v192, v176, v192
    v_pk_add_f16 v193, v177, v193
    v_pk_add_f16 v194, v178, v194
    v_mfma_f32_16x16x32_f16 a[200:203], v[184:187], v[64:67], a[200:203]
    buffer_load_dwordx4 v[168:171], v5, s[28:31], s47 offen offset:0 sc1
    v_mfma_f32_16x16x32_f16 a[204:207], v[184:187], v[68:71], a[204:207]
    v_pk_add_f16 v195, v179, v195
    v_pk_add_f16 v196, v180, v196
    v_pk_add_f16 v197, v181, v197
    v_mfma_f32_16x16x32_f16 a[220:223], v[188:191], v[68:71], a[220:223]
    s_add_u32 s46, s46, s101
    v_pk_add_f16 v198, v182, v198
    v_pk_add_f16 v199, v183, v199
    v_mfma_f32_16x16x32_f16 a[216:219], v[188:191], v[64:67], a[216:219]
    buffer_load_dwordx4 v[172:175], v5, s[28:31], s47 offen offset:1024 sc1
    v_mfma_f32_16x16x32_f16 a[212:215], v[188:191], v[60:63], a[212:215]
    s_waitcnt lgkmcnt(0)
    v_pk_fma_f16 v16, v16, s49, v88
    v_pk_fma_f16 v17, v17, s49, v89
    v_mfma_f32_16x16x32_f16 a[208:211], v[188:191], v[56:59], a[208:211]
    v_pk_fma_f16 v18, v18, s49, v90
    v_pk_fma_f16 v19, v19, s49, v91
    v_pk_fma_f16 v20, v20, s49, v92
    v_mfma_f32_16x16x32_f16 a[224:227], v[192:195], v[56:59], a[224:227]
    v_pk_fma_f16 v21, v21, s49, v93
    v_pk_fma_f16 v22, v22, s49, v94
    v_mfma_f32_16x16x32_f16 a[228:231], v[192:195], v[60:63], a[228:231]
    buffer_load_dwordx4 v[176:179], v5, s[28:31], s47 offen offset:2048 sc1
    v_mfma_f32_16x16x32_f16 a[232:235], v[192:195], v[64:67], a[232:235]
    v_pk_fma_f16 v23, v23, s49, v95
    v_pk_fma_f16 v32, v32, s49, v96
    v_pk_fma_f16 v33, v33, s49, v97
    v_mfma_f32_16x16x32_f16 a[236:239], v[192:195], v[68:71], a[236:239]
    v_pk_fma_f16 v34, v34, s49, v98
    v_pk_fma_f16 v35, v35, s49, v99
    v_mfma_f32_16x16x32_f16 a[252:255], v[196:199], v[68:71], a[252:255]
    buffer_load_dwordx4 v[180:183], v5, s[28:31], s47 offen offset:3072 sc1
    v_mfma_f32_16x16x32_f16 a[248:251], v[196:199], v[64:67], a[248:251]
    s_sub_u32 s50, s50, 1
    v_pk_fma_f16 v36, v36, s49, v100
    v_pk_fma_f16 v37, v37, s49, v101
    v_mfma_f32_16x16x32_f16 a[244:247], v[196:199], v[60:63], a[244:247]
    s_cmp_gt_u32 s50, 1
    v_pk_fma_f16 v38, v38, s49, v102
    v_pk_fma_f16 v39, v39, s49, v103
    v_mfma_f32_16x16x32_f16 a[240:243], v[196:199], v[56:59], a[240:243]
    s_cbranch_scc1 Lloop
    s_cmp_eq_u32 s50, 0
    s_cbranch_scc1 Ltail
    global_load_dword v253, v[234:235], off
    s_branch Lloop
Ltail:
    s_waitcnt vmcnt(22)
    s_barrier
    v_mfma_f32_16x16x32_f16 a[0:3], v[104:107], v[8:11], a[0:3]
    ds_read_b128 v[40:43], v6 offset:24576
    ds_read_b128 v[88:91], v7 offset:24576
    v_pk_add_f16 v72, v8, v24
    v_mfma_f32_16x16x32_f16 a[4:7], v[104:107], v[12:15], a[4:7]
    buffer_load_dwordx4 v[184:187], v5, s[28:31], s48 offen offset:0 sc1
    v_mfma_f32_16x16x32_f16 a[8:11], v[104:107], v[16:19], a[8:11]
    ds_read_b128 v[44:47], v6 offset:25088
    ds_read_b128 v[92:95], v7 offset:25088
    v_pk_add_f16 v73, v9, v25
    v_mfma_f32_16x16x32_f16 a[12:15], v[104:107], v[20:23], a[12:15]
    ds_read_b128 v[56:59], v6 offset:24832
    ds_read_b128 v[96:99], v7 offset:24832
    v_mfma_f32_16x16x32_f16 a[28:31], v[108:111], v[20:23], a[28:31]
    buffer_load_dwordx4 v[188:191], v5, s[28:31], s48 offen offset:1024 sc1
    v_mfma_f32_16x16x32_f16 a[24:27], v[108:111], v[16:19], a[24:27]
    ds_read_b128 v[60:63], v6 offset:25344
    ds_read_b128 v[100:103], v7 offset:25344
    v_pk_add_f16 v74, v10, v26
    v_mfma_f32_16x16x32_f16 a[20:23], v[108:111], v[12:15], a[20:23]
    ds_read_b128 v[48:51], v255 offset:24576
    v_pk_add_f16 v75, v11, v27
    v_pk_add_f16 v76, v12, v28
    v_mfma_f32_16x16x32_f16 a[16:19], v[108:111], v[8:11], a[16:19]
    ds_read_b128 v[52:55], v255 offset:25088
    v_pk_add_f16 v77, v13, v29
    v_mfma_f32_16x16x32_f16 a[32:35], v[112:115], v[8:11], a[32:35]
    buffer_load_dwordx4 v[192:195], v5, s[28:31], s48 offen offset:2048 sc1
    v_mfma_f32_16x16x32_f16 a[36:39], v[112:115], v[12:15], a[36:39]
    ds_read_b128 v[64:67], v255 offset:24832
    v_pk_add_f16 v78, v14, v30
    v_pk_add_f16 v79, v15, v31
    v_mfma_f32_16x16x32_f16 a[40:43], v[112:115], v[16:19], a[40:43]
    ds_read_b128 v[68:71], v255 offset:25344
    v_pk_add_f16 v80, v16, v32
    v_mfma_f32_16x16x32_f16 a[44:47], v[112:115], v[20:23], a[44:47]
    buffer_load_dwordx4 v[196:199], v5, s[28:31], s48 offen offset:3072 sc1
    v_mfma_f32_16x16x32_f16 a[60:63], v[116:119], v[20:23], a[60:63]
    v_pk_add_f16 v81, v17, v33
    v_pk_add_f16 v82, v18, v34
    v_mfma_f32_16x16x32_f16 a[56:59], v[116:119], v[16:19], a[56:59]
    s_add_u32 s48, s48, s101
    v_pk_add_f16 v83, v19, v35
    v_pk_add_f16 v84, v20, v36
    v_pk_add_f16 v85, v21, v37
    v_mfma_f32_16x16x32_f16 a[52:55], v[116:119], v[12:15], a[52:55]
    s_waitcnt vmcnt(22)
    v_pk_add_f16 v86, v22, v38
    v_pk_add_f16 v87, v23, v39
    v_mfma_f32_16x16x32_f16 a[48:51], v[116:119], v[8:11], a[48:51]
    v_and_b32 v252, 127, v237
    v_lshlrev_b32 v239, 1, v252
    v_lshlrev_b32 v252, 5, v252
    v_mfma_f32_16x16x32_f16 a[64:67], v[120:123], v[72:75], a[64:67]
    v_pk_add_f16 v8, v8, v24 neg_lo:[0,1] neg_hi:[0,1]
    v_pk_add_f16 v9, v9, v25 neg_lo:[0,1] neg_hi:[0,1]
    v_pk_add_f16 v10, v10, v26 neg_lo:[0,1] neg_hi:[0,1]
    v_mfma_f32_16x16x32_f16 a[68:71], v[120:123], v[76:79], a[68:71]
    v_pk_add_f16 v11, v11, v27 neg_lo:[0,1] neg_hi:[0,1]
    v_pk_add_f16 v12, v12, v28 neg_lo:[0,1] neg_hi:[0,1]
    v_pk_add_f16 v13, v13, v29 neg_lo:[0,1] neg_hi:[0,1]
    v_mfma_f32_16x16x32_f16 a[72:75], v[120:123], v[80:83], a[72:75]
    s_mul_i32 s59, s3, 9280
    s_add_u32 m0, s59, 114688
    s_lshl_b32 s58, s71, 2
    s_add_u32 s58, s58, s3
    s_mul_i32 s58, s58, 9216
    buffer_load_dwordx4 v1, s[40:43], s58 offen offset:0 nt lds
    v_mfma_f32_16x16x32_f16 a[76:79], v[120:123], v[84:87], a[76:79]
    v_pk_add_f16 v14, v14, v30 neg_lo:[0,1] neg_hi:[0,1]
    v_pk_add_f16 v120, v120, v104 neg_lo:[0,1] neg_hi:[0,1]
    v_pk_add_f16 v121, v121, v105 neg_lo:[0,1] neg_hi:[0,1]
    v_mfma_f32_16x16x32_f16 a[92:95], v[124:127], v[84:87], a[92:95]
    v_pk_add_f16 v122, v122, v106 neg_lo:[0,1] neg_hi:[0,1]
    v_pk_add_f16 v123, v123, v107 neg_lo:[0,1] neg_hi:[0,1]
    v_mfma_f32_16x16x32_f16 a[88:91], v[124:127], v[80:83], a[88:91]
    v_pk_add_f16 v15, v15, v31 neg_lo:[0,1] neg_hi:[0,1]
    v_pk_add_f16 v16, v16, v32 neg_lo:[0,1] neg_hi:[0,1]
    v_xor_b32 v6, 0x10000, v6
    v_mfma_f32_16x16x32_f16 a[84:87], v[124:127], v[76:79], a[84:87]
    s_mul_i32 s56, s54, 4352
    s_lshl_b32 s57, s60, 16
    s_add_u32 s56, s56, s57
    s_add_u32 s56, s56, 0x60000
    v_mfma_f32_16x16x32_f16 a[80:83], v[124:127], v[72:75], a[80:83]
    v_pk_add_f16 v17, v17, v33 neg_lo:[0,1] neg_hi:[0,1]
    v_pk_add_f16 v124, v124, v108 neg_lo:[0,1] neg_hi:[0,1]
    v_pk_add_f16 v125, v125, v109 neg_lo:[0,1] neg_hi:[0,1]
    v_mfma_f32_16x16x32_f16 a[96:99], v[128:131], v[72:75], a[96:99]
    v_pk_add_f16 v126, v126, v110 neg_lo:[0,1] neg_hi:[0,1]
    v_pk_add_f16 v127, v127, v111 neg_lo:[0,1] neg_hi:[0,1]
    v_mfma_f32_16x16x32_f16 a[100:103], v[128:131], v[76:79], a[100:103]
    s_lshl_b32 s57, s53, 3
    s_add_u32 s57, s57, s54
    s_lshl_b32 s57, s57, 12
    s_nop 0
    s_add_u32 s57, s57, 0x10000
    v_mfma_f32_16x16x32_f16 a[104:107], v[128:131], v[80:83], a[104:107]
    v_pk_add_f16 v18, v18, v34 neg_lo:[0,1] neg_hi:[0,1]
    v_pk_add_f16 v19, v19, v35 neg_lo:[0,1] neg_hi:[0,1]
    v_xor_b32 v7, 0x10000, v7
    v_mfma_f32_16x16x32_f16 a[108:111], v[128:131], v[84:87], a[108:111]
    v_pk_add_f16 v20, v20, v36 neg_lo:[0,1] neg_hi:[0,1]
    v_pk_add_f16 v128, v128, v112 neg_lo:[0,1] neg_hi:[0,1]
    v_pk_add_f16 v129, v129, v113 neg_lo:[0,1] neg_hi:[0,1]
    v_mfma_f32_16x16x32_f16 a[124:127], v[132:135], v[84:87], a[124:127]
    v_pk_add_f16 v130, v130, v114 neg_lo:[0,1] neg_hi:[0,1]
    v_pk_add_f16 v131, v131, v115 neg_lo:[0,1] neg_hi:[0,1]
    v_mfma_f32_16x16x32_f16 a[120:123], v[132:135], v[80:83], a[120:123]
    v_and_b32_e64 v251, 15, v0
    v_lshl_add_u32 v251, v251, 8, v239
    v_mfma_f32_16x16x32_f16 a[116:119], v[132:135], v[76:79], a[116:119]
    s_add_u32 s47, s47, s101
    v_pk_add_f16 v21, v21, v37 neg_lo:[0,1] neg_hi:[0,1]
    v_pk_add_f16 v22, v22, v38 neg_lo:[0,1] neg_hi:[0,1]
    v_pk_add_f16 v23, v23, v39 neg_lo:[0,1] neg_hi:[0,1]
    v_mfma_f32_16x16x32_f16 a[112:115], v[132:135], v[72:75], a[112:115]
    s_waitcnt vmcnt(19) lgkmcnt(0)
    v_pk_add_f16 v132, v132, v116 neg_lo:[0,1] neg_hi:[0,1]
    v_pk_add_f16 v133, v133, v117 neg_lo:[0,1] neg_hi:[0,1]
    v_mfma_f32_16x16x32_f16 a[128:131], v[136:139], v[8:11], a[128:131]
    buffer_load_dwordx4 v1, s[40:43], s58 offen offset:1024 nt lds
    v_mfma_f32_16x16x32_f16 a[132:135], v[136:139], v[12:15], a[132:135]
    v_pk_add_f16 v134, v134, v118 neg_lo:[0,1] neg_hi:[0,1]
    v_pk_fma_f16 v40, v88, s49, v40
    v_pk_fma_f16 v41, v89, s49, v41
    v_mfma_f32_16x16x32_f16 a[136:139], v[136:139], v[16:19], a[136:139]
    v_pk_add_f16 v135, v135, v119 neg_lo:[0,1] neg_hi:[0,1]
    v_pk_fma_f16 v42, v90, s49, v42
    v_pk_fma_f16 v43, v91, s49, v43
    v_mfma_f32_16x16x32_f16 a[140:143], v[136:139], v[20:23], a[140:143]
    v_pk_add_f16 v136, v120, v136
    v_pk_fma_f16 v44, v92, s49, v44
    v_pk_fma_f16 v45, v93, s49, v45
    v_mfma_f32_16x16x32_f16 a[156:159], v[140:143], v[20:23], a[156:159]
    buffer_load_dwordx4 v[104:107], v251, s[28:31], s57 offen offset:0 sc1
    v_mfma_f32_16x16x32_f16 a[152:155], v[140:143], v[16:19], a[152:155]
    v_pk_add_f16 v137, v121, v137
    v_pk_fma_f16 v46, v94, s49, v46
    v_pk_fma_f16 v47, v95, s49, v47
    v_mfma_f32_16x16x32_f16 a[148:151], v[140:143], v[12:15], a[148:151]
    v_pk_fma_f16 v56, v96, s49, v56
    v_pk_fma_f16 v57, v97, s49, v57
    v_pk_fma_f16 v58, v98, s49, v58
    v_mfma_f32_16x16x32_f16 a[144:147], v[140:143], v[8:11], a[144:147]
    buffer_load_dwordx4 v[108:111], v251, s[28:31], s57 offen offset:16 sc1
    v_mfma_f32_16x16x32_f16 a[160:163], v[144:147], v[8:11], a[160:163]
    v_pk_add_f16 v138, v122, v138
    v_pk_add_f16 v139, v123, v139
    v_mfma_f32_16x16x32_f16 a[164:167], v[144:147], v[12:15], a[164:167]
    v_pk_fma_f16 v59, v99, s49, v59
    v_pk_fma_f16 v60, v100, s49, v60
    v_xor_b32 v255, 0x10000, v255
    v_mfma_f32_16x16x32_f16 a[168:171], v[144:147], v[16:19], a[168:171]
    v_pk_add_f16 v140, v124, v140
    v_pk_add_f16 v141, v125, v141
    v_mfma_f32_16x16x32_f16 a[172:175], v[144:147], v[20:23], a[172:175]
    buffer_load_dword v232, v252, s[28:31], s56 offen offset:8 sc1
    v_mfma_f32_16x16x32_f16 a[188:191], v[148:151], v[20:23], a[188:191]
    v_pk_fma_f16 v61, v101, s49, v61
    v_pk_fma_f16 v62, v102, s49, v62
    v_pk_fma_f16 v63, v103, s49, v63
    v_mfma_f32_16x16x32_f16 a[184:187], v[148:151], v[16:19], a[184:187]
    v_pk_add_f16 v142, v126, v142
    v_pk_add_f16 v143, v127, v143
    v_mfma_f32_16x16x32_f16 a[180:183], v[148:151], v[12:15], a[180:183]
    buffer_load_dword v233, v252, s[28:31], s56 offen offset:264 sc1
    v_mfma_f32_16x16x32_f16 a[176:179], v[148:151], v[8:11], a[176:179]
    s_mov_b64 exec, s[4:5]
    ds_read_b128 v[88:91], v254 offset:24576
    ds_read_b128 v[92:95], v254 offset:25088
    s_mov_b64 exec, -1
    v_mfma_f32_16x16x32_f16 a[192:195], v[136:139], v[24:27], a[192:195]
    s_mov_b64 exec, s[4:5]
    ds_read_b128 v[96:99], v254 offset:24832
    ds_read_b128 v[100:103], v254 offset:25344
    s_mov_b64 exec, -1
    v_mfma_f32_16x16x32_f16 a[196:199], v[136:139], v[28:31], a[196:199]
    v_pk_add_f16 v144, v128, v144
    v_pk_add_f16 v145, v129, v145
    v_pk_add_f16 v146, v130, v146
    v_mfma_f32_16x16x32_f16 a[200:203], v[136:139], v[32:35], a[200:203]
    v_mfma_f32_16x16x32_f16 a[204:207], v[136:139], v[36:39], a[204:207]
    v_pk_add_f16 v147, v131, v147
    v_pk_add_f16 v148, v132, v148
    v_pk_add_f16 v149, v133, v149
    v_mfma_f32_16x16x32_f16 a[220:223], v[140:143], v[36:39], a[220:223]
    s_add_u32 s46, s46, s101
    v_pk_add_f16 v150, v134, v150
    v_pk_add_f16 v151, v135, v151
    v_mfma_f32_16x16x32_f16 a[216:219], v[140:143], v[32:35], a[216:219]
    buffer_load_dwordx4 v1, s[40:43], s58 offen offset:2048 nt lds
    v_mfma_f32_16x16x32_f16 a[212:215], v[140:143], v[28:31], a[212:215]
    s_waitcnt lgkmcnt(0)
    v_pk_fma_f16 v48, v48, s49, v88
    v_pk_fma_f16 v49, v49, s49, v89
    v_mfma_f32_16x16x32_f16 a[208:211], v[140:143], v[24:27], a[208:211]
    v_pk_fma_f16 v50, v50, s49, v90
    v_pk_fma_f16 v51, v51, s49, v91
    v_pk_fma_f16 v52, v52, s49, v92
    v_mfma_f32_16x16x32_f16 a[224:227], v[144:147], v[24:27], a[224:227]
    v_pk_fma_f16 v53, v53, s49, v93
    v_pk_fma_f16 v54, v54, s49, v94
    v_xor_b32 v254, 0x10000, v254
    v_mfma_f32_16x16x32_f16 a[228:231], v[144:147], v[28:31], a[228:231]
    v_mfma_f32_16x16x32_f16 a[232:235], v[144:147], v[32:35], a[232:235]
    v_pk_fma_f16 v55, v55, s49, v95
    v_pk_fma_f16 v64, v64, s49, v96
    v_pk_fma_f16 v65, v65, s49, v97
    v_mfma_f32_16x16x32_f16 a[236:239], v[144:147], v[36:39], a[236:239]
    v_pk_fma_f16 v66, v66, s49, v98
    v_pk_fma_f16 v67, v67, s49, v99
    v_mfma_f32_16x16x32_f16 a[252:255], v[148:151], v[36:39], a[252:255]
    v_mfma_f32_16x16x32_f16 a[248:251], v[148:151], v[32:35], a[248:251]
    v_pk_fma_f16 v68, v68, s49, v100
    v_pk_fma_f16 v69, v69, s49, v101
    v_mfma_f32_16x16x32_f16 a[244:247], v[148:151], v[28:31], a[244:247]
    v_pk_fma_f16 v70, v70, s49, v102
    v_pk_fma_f16 v71, v71, s49, v103
    v_mfma_f32_16x16x32_f16 a[240:243], v[148:151], v[24:27], a[240:243]
    buffer_load_dwordx4 v1, s[40:43], s58 offen offset:3072 nt lds
    s_waitcnt vmcnt(16)
    s_barrier
    v_mfma_f32_16x16x32_f16 a[0:3], v[152:155], v[40:43], a[0:3]
    v_pk_add_f16 v72, v40, v56
    v_pk_add_f16 v73, v41, v57
    v_mfma_f32_16x16x32_f16 a[4:7], v[152:155], v[44:47], a[4:7]
    v_mfma_f32_16x16x32_f16 a[8:11], v[152:155], v[48:51], a[8:11]
    global_load_dwordx4 v[124:127], v237, s[16:17]
    v_mfma_f32_16x16x32_f16 a[12:15], v[152:155], v[52:55], a[12:15]
    v_pk_add_f16 v74, v42, v58
    v_pk_add_f16 v75, v43, v59
    v_mfma_f32_16x16x32_f16 a[28:31], v[156:159], v[52:55], a[28:31]
    v_mfma_f32_16x16x32_f16 a[24:27], v[156:159], v[48:51], a[24:27]
    global_load_dwordx4 v[128:131], v237, s[18:19]
    v_mfma_f32_16x16x32_f16 a[20:23], v[156:159], v[44:47], a[20:23]
    v_pk_add_f16 v76, v44, v60
    v_pk_add_f16 v77, v45, v61
    v_mfma_f32_16x16x32_f16 a[16:19], v[156:159], v[40:43], a[16:19]
    v_pk_add_f16 v78, v46, v62
    v_pk_add_f16 v79, v47, v63
    v_mfma_f32_16x16x32_f16 a[32:35], v[160:163], v[40:43], a[32:35]
    v_mfma_f32_16x16x32_f16 a[36:39], v[160:163], v[44:47], a[36:39]
    s_add_u32 m0, s59, 118784
    s_add_u32 s58, s58, 4096
    buffer_load_dwordx4 v1, s[40:43], s58 offen offset:0 nt lds
    v_mfma_f32_16x16x32_f16 a[40:43], v[160:163], v[48:51], a[40:43]
    v_pk_add_f16 v80, v48, v64
    v_pk_add_f16 v81, v49, v65
    v_mfma_f32_16x16x32_f16 a[44:47], v[160:163], v[52:55], a[44:47]
    v_mfma_f32_16x16x32_f16 a[60:63], v[164:167], v[52:55], a[60:63]
    v_pk_add_f16 v82, v50, v66
    v_pk_add_f16 v83, v51, v67
    v_mfma_f32_16x16x32_f16 a[56:59], v[164:167], v[48:51], a[56:59]
    s_add_u32 s48, s48, s101
    v_pk_add_f16 v84, v52, v68
    v_pk_add_f16 v85, v53, v69
    v_mfma_f32_16x16x32_f16 a[52:55], v[164:167], v[44:47], a[52:55]
    s_waitcnt vmcnt(15)
    v_pk_add_f16 v86, v54, v70
    v_pk_add_f16 v87, v55, v71
    v_mfma_f32_16x16x32_f16 a[48:51], v[164:167], v[40:43], a[48:51]
    v_mfma_f32_16x16x32_f16 a[64:67], v[168:171], v[72:75], a[64:67]
    v_pk_add_f16 v40, v40, v56 neg_lo:[0,1] neg_hi:[0,1]
    v_pk_add_f16 v41, v41, v57 neg_lo:[0,1] neg_hi:[0,1]
    v_mfma_f32_16x16x32_f16 a[68:71], v[168:171], v[76:79], a[68:71]
    v_pk_add_f16 v42, v42, v58 neg_lo:[0,1] neg_hi:[0,1]
    v_pk_add_f16 v43, v43, v59 neg_lo:[0,1] neg_hi:[0,1]
    v_mfma_f32_16x16x32_f16 a[72:75], v[168:171], v[80:83], a[72:75]
    v_pk_add_f16 v44, v44, v60 neg_lo:[0,1] neg_hi:[0,1]
    v_pk_add_f16 v45, v45, v61 neg_lo:[0,1] neg_hi:[0,1]
    v_mfma_f32_16x16x32_f16 a[76:79], v[168:171], v[84:87], a[76:79]
    v_pk_add_f16 v168, v168, v152 neg_lo:[0,1] neg_hi:[0,1]
    v_pk_add_f16 v169, v169, v153 neg_lo:[0,1] neg_hi:[0,1]
    v_mfma_f32_16x16x32_f16 a[92:95], v[172:175], v[84:87], a[92:95]
    v_pk_add_f16 v170, v170, v154 neg_lo:[0,1] neg_hi:[0,1]
    v_pk_add_f16 v171, v171, v155 neg_lo:[0,1] neg_hi:[0,1]
    v_mfma_f32_16x16x32_f16 a[88:91], v[172:175], v[80:83], a[88:91]
    v_pk_add_f16 v46, v46, v62 neg_lo:[0,1] neg_hi:[0,1]
    v_pk_add_f16 v47, v47, v63 neg_lo:[0,1] neg_hi:[0,1]
    v_mfma_f32_16x16x32_f16 a[84:87], v[172:175], v[76:79], a[84:87]
    buffer_load_dwordx4 v1, s[40:43], s58 offen offset:1024 nt lds
    v_mfma_f32_16x16x32_f16 a[80:83], v[172:175], v[72:75], a[80:83]
    v_pk_add_f16 v172, v172, v156 neg_lo:[0,1] neg_hi:[0,1]
    v_pk_add_f16 v173, v173, v157 neg_lo:[0,1] neg_hi:[0,1]
    v_mfma_f32_16x16x32_f16 a[96:99], v[176:179], v[72:75], a[96:99]
    v_pk_add_f16 v174, v174, v158 neg_lo:[0,1] neg_hi:[0,1]
    v_pk_add_f16 v175, v175, v159 neg_lo:[0,1] neg_hi:[0,1]
    v_mfma_f32_16x16x32_f16 a[100:103], v[176:179], v[76:79], a[100:103]
    v_pk_add_f16 v48, v48, v64 neg_lo:[0,1] neg_hi:[0,1]
    v_pk_add_f16 v49, v49, v65 neg_lo:[0,1] neg_hi:[0,1]
    v_mfma_f32_16x16x32_f16 a[104:107], v[176:179], v[80:83], a[104:107]
    v_pk_add_f16 v50, v50, v66 neg_lo:[0,1] neg_hi:[0,1]
    v_pk_add_f16 v51, v51, v67 neg_lo:[0,1] neg_hi:[0,1]
    v_mfma_f32_16x16x32_f16 a[108:111], v[176:179], v[84:87], a[108:111]
    v_pk_add_f16 v176, v176, v160 neg_lo:[0,1] neg_hi:[0,1]
    v_pk_add_f16 v177, v177, v161 neg_lo:[0,1] neg_hi:[0,1]
    v_mfma_f32_16x16x32_f16 a[124:127], v[180:183], v[84:87], a[124:127]
    v_pk_add_f16 v178, v178, v162 neg_lo:[0,1] neg_hi:[0,1]
    v_pk_add_f16 v179, v179, v163 neg_lo:[0,1] neg_hi:[0,1]
    v_mfma_f32_16x16x32_f16 a[120:123], v[180:183], v[80:83], a[120:123]
    v_pk_add_f16 v52, v52, v68 neg_lo:[0,1] neg_hi:[0,1]
    v_pk_add_f16 v53, v53, v69 neg_lo:[0,1] neg_hi:[0,1]
    v_mfma_f32_16x16x32_f16 a[116:119], v[180:183], v[76:79], a[116:119]
    s_add_u32 s47, s47, s101
    v_pk_add_f16 v54, v54, v70 neg_lo:[0,1] neg_hi:[0,1]
    v_pk_add_f16 v55, v55, v71 neg_lo:[0,1] neg_hi:[0,1]
    v_mfma_f32_16x16x32_f16 a[112:115], v[180:183], v[72:75], a[112:115]
    s_waitcnt vmcnt(12)
    v_pk_add_f16 v180, v180, v164 neg_lo:[0,1] neg_hi:[0,1]
    v_pk_add_f16 v181, v181, v165 neg_lo:[0,1] neg_hi:[0,1]
    v_mfma_f32_16x16x32_f16 a[128:131], v[184:187], v[40:43], a[128:131]
    v_pk_add_f16 v182, v182, v166 neg_lo:[0,1] neg_hi:[0,1]
    v_pk_add_f16 v183, v183, v167 neg_lo:[0,1] neg_hi:[0,1]
    v_mfma_f32_16x16x32_f16 a[132:135], v[184:187], v[44:47], a[132:135]
    buffer_load_dwordx4 v1, s[40:43], s58 offen offset:2048 nt lds
    v_mfma_f32_16x16x32_f16 a[136:139], v[184:187], v[48:51], a[136:139]
    v_mfma_f32_16x16x32_f16 a[140:143], v[184:187], v[52:55], a[140:143]
    v_pk_add_f16 v184, v168, v184
    v_pk_add_f16 v185, v169, v185
    v_mfma_f32_16x16x32_f16 a[156:159], v[188:191], v[52:55], a[156:159]
    v_mfma_f32_16x16x32_f16 a[152:155], v[188:191], v[48:51], a[152:155]
    v_pk_add_f16 v186, v170, v186
    v_pk_add_f16 v187, v171, v187
    v_mfma_f32_16x16x32_f16 a[148:151], v[188:191], v[44:47], a[148:151]
    v_mfma_f32_16x16x32_f16 a[144:147], v[188:191], v[40:43], a[144:147]
    s_waitcnt vmcnt(7)
    s_nop 0
    v_pk_mul_f32 v[232:233], v[232:233], s[62:63] op_sel:[0,1] op_sel_hi:[1,1]
    v_mfma_f32_16x16x32_f16 a[160:163], v[192:195], v[40:43], a[160:163]
    v_pk_add_f16 v188, v172, v188
    v_pk_add_f16 v189, v173, v189
    v_mfma_f32_16x16x32_f16 a[164:167], v[192:195], v[44:47], a[164:167]
    v_pk_add_f16 v190, v174, v190
    v_pk_add_f16 v191, v175, v191
    v_mfma_f32_16x16x32_f16 a[168:171], v[192:195], v[48:51], a[168:171]
    buffer_load_dwordx4 v1, s[40:43], s58 offen offset:3072 nt lds
    v_mfma_f32_16x16x32_f16 a[172:175], v[192:195], v[52:55], a[172:175]
    v_add_f32_dpp v104, v104, v104 row_ror:8 row_mask:0xf bank_mask:0xf
    v_add_f32_dpp v105, v105, v105 row_ror:8 row_mask:0xf bank_mask:0xf
    v_mfma_f32_16x16x32_f16 a[188:191], v[196:199], v[52:55], a[188:191]
    v_pk_add_f16 v192, v176, v192
    v_pk_add_f16 v193, v177, v193
    v_mfma_f32_16x16x32_f16 a[184:187], v[196:199], v[48:51], a[184:187]
    v_pk_add_f16 v194, v178, v194
    v_pk_add_f16 v195, v179, v195
    v_mfma_f32_16x16x32_f16 a[180:183], v[196:199], v[44:47], a[180:183]
    v_add_f32_dpp v106, v106, v106 row_ror:8 row_mask:0xf bank_mask:0xf
    v_add_f32_dpp v107, v107, v107 row_ror:8 row_mask:0xf bank_mask:0xf
    v_mfma_f32_16x16x32_f16 a[176:179], v[196:199], v[40:43], a[176:179]
    v_pk_add_f16 v196, v180, v196
    v_pk_add_f16 v197, v181, v197
    v_mfma_f32_16x16x32_f16 a[192:195], v[184:187], v[56:59], a[192:195]
    v_pk_add_f16 v198, v182, v198
    v_pk_add_f16 v199, v183, v199
    v_mfma_f32_16x16x32_f16 a[196:199], v[184:187], v[60:63], a[196:199]
    v_add_f32_dpp v108, v108, v108 row_ror:8 row_mask:0xf bank_mask:0xf
    v_add_f32_dpp v109, v109, v109 row_ror:8 row_mask:0xf bank_mask:0xf
    v_mfma_f32_16x16x32_f16 a[200:203], v[184:187], v[64:67], a[200:203]
    v_add_f32_dpp v110, v110, v110 row_ror:8 row_mask:0xf bank_mask:0xf
    v_add_f32_dpp v111, v111, v111 row_ror:8 row_mask:0xf bank_mask:0xf
    v_mfma_f32_16x16x32_f16 a[204:207], v[184:187], v[68:71], a[204:207]
    v_add_f32_dpp v104, v104, v104 row_ror:4 row_mask:0xf bank_mask:0xf
    v_add_f32_dpp v105, v105, v105 row_ror:4 row_mask:0xf bank_mask:0xf
    v_mfma_f32_16x16x32_f16 a[220:223], v[188:191], v[68:71], a[220:223]
    v_add_f32_dpp v106, v106, v106 row_ror:4 row_mask:0xf bank_mask:0xf
    v_add_f32_dpp v107, v107, v107 row_ror:4 row_mask:0xf bank_mask:0xf
    v_mfma_f32_16x16x32_f16 a[216:219], v[188:191], v[64:67], a[216:219]
    v_add_f32_dpp v108, v108, v108 row_ror:4 row_mask:0xf bank_mask:0xf
    v_add_f32_dpp v109, v109, v109 row_ror:4 row_mask:0xf bank_mask:0xf
    v_mfma_f32_16x16x32_f16 a[212:215], v[188:191], v[60:63], a[212:215]
    v_add_f32_dpp v110, v110, v110 row_ror:4 row_mask:0xf bank_mask:0xf
    v_add_f32_dpp v111, v111, v111 row_ror:4 row_mask:0xf bank_mask:0xf
    v_mfma_f32_16x16x32_f16 a[208:211], v[188:191], v[56:59], a[208:211]
    s_add_u32 m0, s59, 122880
    s_add_u32 s58, s58, 4096
    buffer_load_dwordx4 v1, s[40:43], s58 offen offset:0 nt lds
    v_mfma_f32_16x16x32_f16 a[224:227], v[192:195], v[56:59], a[224:227]
    v_add_f32_dpp v104, v104, v104 row_ror:2 row_mask:0xf bank_mask:0xf
    v_add_f32_dpp v105, v105, v105 row_ror:2 row_mask:0xf bank_mask:0xf
    v_mfma_f32_16x16x32_f16 a[228:231], v[192:195], v[60:63], a[228:231]
    v_add_f32_dpp v106, v106, v106 row_ror:2 row_mask:0xf bank_mask:0xf
    v_add_f32_dpp v107, v107, v107 row_ror:2 row_mask:0xf bank_mask:0xf
    v_mfma_f32_16x16x32_f16 a[232:235], v[192:195], v[64:67], a[232:235]
    v_add_f32_dpp v108, v108, v108 row_ror:2 row_mask:0xf bank_mask:0xf
    v_add_f32_dpp v109, v109, v109 row_ror:2 row_mask:0xf bank_mask:0xf
    v_mfma_f32_16x16x32_f16 a[236:239], v[192:195], v[68:71], a[236:239]
    v_add_f32_dpp v110, v110, v110 row_ror:2 row_mask:0xf bank_mask:0xf
    v_add_f32_dpp v111, v111, v111 row_ror:2 row_mask:0xf bank_mask:0xf
    v_mfma_f32_16x16x32_f16 a[252:255], v[196:199], v[68:71], a[252:255]
    v_add_f32_dpp v104, v104, v104 row_ror:1 row_mask:0xf bank_mask:0xf
    v_add_f32_dpp v105, v105, v105 row_ror:1 row_mask:0xf bank_mask:0xf
    v_mfma_f32_16x16x32_f16 a[248:251], v[196:199], v[64:67], a[248:251]
    v_add_f32_dpp v106, v106, v106 row_ror:1 row_mask:0xf bank_mask:0xf
    v_add_f32_dpp v107, v107, v107 row_ror:1 row_mask:0xf bank_mask:0xf
    v_mfma_f32_16x16x32_f16 a[244:247], v[196:199], v[60:63], a[244:247]
    v_add_f32_dpp v108, v108, v108 row_ror:1 row_mask:0xf bank_mask:0xf
    v_add_f32_dpp v109, v109, v109 row_ror:1 row_mask:0xf bank_mask:0xf
    v_mfma_f32_16x16x32_f16 a[240:243], v[196:199], v[56:59], a[240:243]
    v_add_f32_dpp v110, v110, v110 row_ror:1 row_mask:0xf bank_mask:0xf
    v_add_f32_dpp v111, v111, v111 row_ror:1 row_mask:0xf bank_mask:0xf
Lepi:
    v_accvgpr_read_b32 v8, a8
    v_accvgpr_read_b32 v9, a9
    v_accvgpr_read_b32 v10, a10
    v_accvgpr_read_b32 v11, a11
    v_accvgpr_read_b32 v12, a12
    v_accvgpr_read_b32 v13, a13
    v_accvgpr_read_b32 v14, a14
    v_accvgpr_read_b32 v15, a15
    v_accvgpr_read_b32 v16, a72
    v_accvgpr_read_b32 v17, a73
    v_accvgpr_read_b32 v18, a74
    v_accvgpr_read_b32 v19, a75
    v_accvgpr_read_b32 v24, a136
    v_accvgpr_read_b32 v25, a137
    v_accvgpr_read_b32 v26, a138
    v_accvgpr_read_b32 v27, a139
    v_pk_add_f32 v[76:77], v[16:17], v[24:25]
    v_pk_add_f32 v[78:79], v[18:19], v[26:27]
    v_pk_add_f32 v[72:73], v[16:17], v[24:25] neg_lo:[0,1] neg_hi:[0,1]
    v_pk_add_f32 v[74:75], v[18:19], v[26:27] neg_lo:[0,1] neg_hi:[0,1]
    v_pk_add_f32 v[76:77], v[76:77], v[8:9] neg_lo:[0,1] neg_hi:[0,1]
    v_pk_add_f32 v[78:79], v[78:79], v[10:11] neg_lo:[0,1] neg_hi:[0,1]
    v_pk_add_f32 v[76:77], v[76:77], v[12:13]
    v_pk_add_f32 v[78:79], v[78:79], v[14:15]
    ds_write_b128 v241, v[76:79] offset:1024
    v_accvgpr_read_b32 v36, a204
    v_accvgpr_read_b32 v37, a205
    v_accvgpr_read_b32 v38, a206
    v_accvgpr_read_b32 v39, a207
    v_accvgpr_read_b32 v32, a200
    v_accvgpr_read_b32 v33, a201
    v_accvgpr_read_b32 v34, a202
    v_accvgpr_read_b32 v35, a203
    v_add_f32_dpp v72, v36, v72 row_shr:1 row_mask:0xf bank_mask:0xf bound_ctrl:1
    v_add_f32_dpp v73, v37, v73 row_shr:1 row_mask:0xf bank_mask:0xf bound_ctrl:1
    v_add_f32_dpp v74, v38, v74 row_shr:1 row_mask:0xf bank_mask:0xf bound_ctrl:1
    v_add_f32_dpp v75, v39, v75 row_shr:1 row_mask:0xf bank_mask:0xf bound_ctrl:1
    v_pk_add_f32 v[72:73], v[72:73], v[32:33] neg_lo:[0,1] neg_hi:[0,1]
    v_pk_add_f32 v[74:75], v[74:75], v[34:35] neg_lo:[0,1] neg_hi:[0,1]
    ds_write_b128 v241, v[72:75] offset:0
    v_accvgpr_read_b32 v20, a76
    v_accvgpr_read_b32 v21, a77
    v_accvgpr_read_b32 v22, a78
    v_accvgpr_read_b32 v23, a79
    v_accvgpr_read_b32 v28, a140
    v_accvgpr_read_b32 v29, a141
    v_accvgpr_read_b32 v30, a142
    v_accvgpr_read_b32 v31, a143
    v_pk_add_f32 v[80:81], v[20:21], v[28:29] neg_lo:[0,1] neg_hi:[0,1]
    v_pk_add_f32 v[82:83], v[22:23], v[30:31] neg_lo:[0,1] neg_hi:[0,1]
    v_pk_add_f32 v[84:85], v[20:21], v[28:29]
    v_pk_add_f32 v[86:87], v[22:23], v[30:31]
    v_pk_add_f32 v[80:81], v[80:81], v[36:37] neg_lo:[0,1] neg_hi:[0,1]
    v_pk_add_f32 v[82:83], v[82:83], v[38:39] neg_lo:[0,1] neg_hi:[0,1]
    v_pk_add_f32 v[80:81], v[80:81], v[32:33]
    v_pk_add_f32 v[82:83], v[82:83], v[34:35]
    ds_write_b128 v241, v[80:83] offset:2048
    v_add_f32_dpp v84, v8, v84 row_shl:1 row_mask:0xf bank_mask:0xf bound_ctrl:1
    v_add_f32_dpp v85, v9, v85 row_shl:1 row_mask:0xf bank_mask:0xf bound_ctrl:1
    v_add_f32_dpp v86, v10, v86 row_shl:1 row_mask:0xf bank_mask:0xf bound_ctrl:1
    v_add_f32_dpp v87, v11, v87 row_shl:1 row_mask:0xf bank_mask:0xf bound_ctrl:1
    v_pk_add_f32 v[84:85], v[84:85], v[12:13] neg_lo:[0,1] neg_hi:[0,1]
    v_pk_add_f32 v[86:87], v[86:87], v[14:15] neg_lo:[0,1] neg_hi:[0,1]
    v_accvgpr_read_b32 v40, a32
    v_accvgpr_read_b32 v41, a33
    v_accvgpr_read_b32 v42, a34
    v_accvgpr_read_b32 v43, a35
    v_accvgpr_read_b32 v44, a36
    v_accvgpr_read_b32 v45, a37
    v_accvgpr_read_b32 v46, a38
    ds_write_b128 v241, v[84:87] offset:3072
    v_accvgpr_read_b32 v47, a39
    v_accvgpr_read_b32 v48, a96
    v_accvgpr_read_b32 v49, a97
    v_accvgpr_read_b32 v50, a98
    v_accvgpr_read_b32 v51, a99
    v_accvgpr_read_b32 v56, a160
    v_accvgpr_read_b32 v57, a161
    v_accvgpr_read_b32 v58, a162
    v_accvgpr_read_b32 v59, a163
    v_pk_add_f32 v[92:93], v[48:49], v[56:57]
    v_pk_add_f32 v[94:95], v[50:51], v[58:59]
    v_pk_add_f32 v[88:89], v[48:49], v[56:57] neg_lo:[0,1] neg_hi:[0,1]
    v_pk_add_f32 v[90:91], v[50:51], v[58:59] neg_lo:[0,1] neg_hi:[0,1]
    v_pk_add_f32 v[92:93], v[92:93], v[40:41] neg_lo:[0,1] neg_hi:[0,1]
    v_pk_add_f32 v[94:95], v[94:95], v[42:43] neg_lo:[0,1] neg_hi:[0,1]
    v_pk_add_f32 v[92:93], v[92:93], v[44:45]
    v_pk_add_f32 v[94:95], v[94:95], v[46:47]
    ds_write_b128 v240, v[92:95] offset:1024
    v_accvgpr_read_b32 v68, a228
    v_accvgpr_read_b32 v69, a229
    v_accvgpr_read_b32 v70, a230
    v_accvgpr_read_b32 v71, a231
    v_accvgpr_read_b32 v64, a224
    v_accvgpr_read_b32 v65, a225
    v_accvgpr_read_b32 v66, a226
    v_accvgpr_read_b32 v67, a227
    v_add_f32_dpp v88, v68, v88 row_shr:1 row_mask:0xf bank_mask:0xf bound_ctrl:1
    v_add_f32_dpp v89, v69, v89 row_shr:1 row_mask:0xf bank_mask:0xf bound_ctrl:1
    v_add_f32_dpp v90, v70, v90 row_shr:1 row_mask:0xf bank_mask:0xf bound_ctrl:1
    v_add_f32_dpp v91, v71, v91 row_shr:1 row_mask:0xf bank_mask:0xf bound_ctrl:1
    v_pk_add_f32 v[88:89], v[88:89], v[64:65] neg_lo:[0,1] neg_hi:[0,1]
    v_pk_add_f32 v[90:91], v[90:91], v[66:67] neg_lo:[0,1] neg_hi:[0,1]
    ds_write_b128 v240, v[88:91] offset:0
    v_accvgpr_read_b32 v52, a100
    v_accvgpr_read_b32 v53, a101
    v_accvgpr_read_b32 v54, a102
    v_accvgpr_read_b32 v55, a103
    v_accvgpr_read_b32 v60, a164
    v_accvgpr_read_b32 v61, a165
    v_accvgpr_read_b32 v62, a166
    v_accvgpr_read_b32 v63, a167
    v_pk_add_f32 v[96:97], v[52:53], v[60:61] neg_lo:[0,1] neg_hi:[0,1]
    v_pk_add_f32 v[98:99], v[54:55], v[62:63] neg_lo:[0,1] neg_hi:[0,1]
    v_pk_add_f32 v[100:101], v[52:53], v[60:61]
    v_pk_add_f32 v[102:103], v[54:55], v[62:63]
    v_pk_add_f32 v[96:97], v[96:97], v[68:69] neg_lo:[0,1] neg_hi:[0,1]
    v_pk_add_f32 v[98:99], v[98:99], v[70:71] neg_lo:[0,1] neg_hi:[0,1]
    v_pk_add_f32 v[96:97], v[96:97], v[64:65]
    v_pk_add_f32 v[98:99], v[98:99], v[66:67]
    ds_write_b128 v240, v[96:99] offset:2048
    v_add_f32_dpp v100, v40, v100 row_shl:1 row_mask:0xf bank_mask:0xf bound_ctrl:1
    v_add_f32_dpp v101, v41, v101 row_shl:1 row_mask:0xf bank_mask:0xf bound_ctrl:1
    v_add_f32_dpp v102, v42, v102 row_shl:1 row_mask:0xf bank_mask:0xf bound_ctrl:1
    v_add_f32_dpp v103, v43, v103 row_shl:1 row_mask:0xf bank_mask:0xf bound_ctrl:1
    v_pk_add_f32 v[100:101], v[100:101], v[44:45] neg_lo:[0,1] neg_hi:[0,1]
    v_pk_add_f32 v[102:103], v[102:103], v[46:47] neg_lo:[0,1] neg_hi:[0,1]
    v_accvgpr_read_b32 v8, a40
    v_accvgpr_read_b32 v9, a41
    v_accvgpr_read_b32 v10, a42
    v_accvgpr_read_b32 v11, a43
    v_accvgpr_read_b32 v12, a44
    v_accvgpr_read_b32 v13, a45
    v_accvgpr_read_b32 v14, a46
    ds_write_b128 v240, v[100:103] offset:3072
    v_accvgpr_read_b32 v15, a47
    v_accvgpr_read_b32 v16, a104
    v_accvgpr_read_b32 v17, a105
    v_accvgpr_read_b32 v18, a106
    v_accvgpr_read_b32 v19, a107
    v_accvgpr_read_b32 v24, a168
    v_accvgpr_read_b32 v25, a169
    v_accvgpr_read_b32 v26, a170
    v_accvgpr_read_b32 v27, a171
    s_waitcnt lgkmcnt(4)
    s_nop 0
    v_pk_add_f32 v[76:77], v[16:17], v[24:25]
    v_pk_add_f32 v[78:79], v[18:19], v[26:27]
    v_pk_add_f32 v[72:73], v[16:17], v[24:25] neg_lo:[0,1] neg_hi:[0,1]
    v_pk_add_f32 v[74:75], v[18:19], v[26:27] neg_lo:[0,1] neg_hi:[0,1]
    v_pk_add_f32 v[76:77], v[76:77], v[8:9] neg_lo:[0,1] neg_hi:[0,1]
    v_pk_add_f32 v[78:79], v[78:79], v[10:11] neg_lo:[0,1] neg_hi:[0,1]
    v_pk_add_f32 v[76:77], v[76:77], v[12:13]
    v_pk_add_f32 v[78:79], v[78:79], v[14:15]
    ds_write_b128 v242, v[76:79] offset:1024
    v_accvgpr_read_b32 v36, a236
    v_accvgpr_read_b32 v37, a237
    v_accvgpr_read_b32 v38, a238
    v_accvgpr_read_b32 v39, a239
    v_accvgpr_read_b32 v32, a232
    v_accvgpr_read_b32 v33, a233
    v_accvgpr_read_b32 v34, a234
    v_accvgpr_read_b32 v35, a235
    v_add_f32_dpp v72, v36, v72 row_shr:1 row_mask:0xf bank_mask:0xf bound_ctrl:1
    v_add_f32_dpp v73, v37, v73 row_shr:1 row_mask:0xf bank_mask:0xf bound_ctrl:1
    v_add_f32_dpp v74, v38, v74 row_shr:1 row_mask:0xf bank_mask:0xf bound_ctrl:1
    v_add_f32_dpp v75, v39, v75 row_shr:1 row_mask:0xf bank_mask:0xf bound_ctrl:1
    v_pk_add_f32 v[72:73], v[72:73], v[32:33] neg_lo:[0,1] neg_hi:[0,1]
    v_pk_add_f32 v[74:75], v[74:75], v[34:35] neg_lo:[0,1] neg_hi:[0,1]
    ds_write_b128 v242, v[72:75] offset:0
    v_accvgpr_read_b32 v20, a108
    v_accvgpr_read_b32 v21, a109
    v_accvgpr_read_b32 v22, a110
    v_accvgpr_read_b32 v23, a111
    v_accvgpr_read_b32 v28, a172
    v_accvgpr_read_b32 v29, a173
    v_accvgpr_read_b32 v30, a174
    v_accvgpr_read_b32 v31, a175
    v_pk_add_f32 v[80:81], v[20:21], v[28:29] neg_lo:[0,1] neg_hi:[0,1]
    v_pk_add_f32 v[82:83], v[22:23], v[30:31] neg_lo:[0,1] neg_hi:[0,1]
    v_pk_add_f32 v[84:85], v[20:21], v[28:29]
    v_pk_add_f32 v[86:87], v[22:23], v[30:31]
    v_pk_add_f32 v[80:81], v[80:81], v[36:37] neg_lo:[0,1] neg_hi:[0,1]
    v_pk_add_f32 v[82:83], v[82:83], v[38:39] neg_lo:[0,1] neg_hi:[0,1]
    v_pk_add_f32 v[80:81], v[80:81], v[32:33]
    v_pk_add_f32 v[82:83], v[82:83], v[34:35]
    ds_write_b128 v242, v[80:83] offset:2048
    v_add_f32_dpp v84, v8, v84 row_shl:1 row_mask:0xf bank_mask:0xf bound_ctrl:1
    v_add_f32_dpp v85, v9, v85 row_shl:1 row_mask:0xf bank_mask:0xf bound_ctrl:1
    v_add_f32_dpp v86, v10, v86 row_shl:1 row_mask:0xf bank_mask:0xf bound_ctrl:1
    v_add_f32_dpp v87, v11, v87 row_shl:1 row_mask:0xf bank_mask:0xf bound_ctrl:1
    v_pk_add_f32 v[84:85], v[84:85], v[12:13] neg_lo:[0,1] neg_hi:[0,1]
    v_pk_add_f32 v[86:87], v[86:87], v[14:15] neg_lo:[0,1] neg_hi:[0,1]
    v_accvgpr_read_b32 v40, a0
    v_accvgpr_read_b32 v41, a1
    v_accvgpr_read_b32 v42, a2
    v_accvgpr_read_b32 v43, a3
    v_accvgpr_read_b32 v44, a4
    v_accvgpr_read_b32 v45, a5
    v_accvgpr_read_b32 v46, a6
    ds_write_b128 v242, v[84:87] offset:3072
    v_accvgpr_read_b32 v47, a7
    v_accvgpr_read_b32 v48, a64
    v_accvgpr_read_b32 v49, a65
    v_accvgpr_read_b32 v50, a66
    v_accvgpr_read_b32 v51, a67
    v_accvgpr_read_b32 v56, a128
    v_accvgpr_read_b32 v57, a129
    v_accvgpr_read_b32 v58, a130
    v_accvgpr_read_b32 v59, a131
    v_pk_add_f32 v[144:145], v[48:49], v[56:57]
    v_pk_add_f32 v[146:147], v[50:51], v[58:59]
    v_pk_add_f32 v[136:137], v[48:49], v[56:57] neg_lo:[0,1] neg_hi:[0,1]
    v_pk_add_f32 v[138:139], v[50:51], v[58:59] neg_lo:[0,1] neg_hi:[0,1]
    v_pk_add_f32 v[144:145], v[144:145], v[40:41] neg_lo:[0,1] neg_hi:[0,1]
    s_waitcnt lgkmcnt(0)
    s_barrier
    ds_read_b128 v[8:11], v243 offset:0
    ds_read_b128 v[12:15], v244 offset:0
    ds_read_b128 v[16:19], v245 offset:0
    v_pk_add_f32 v[146:147], v[146:147], v[42:43] neg_lo:[0,1] neg_hi:[0,1]
    v_pk_add_f32 v[144:145], v[144:145], v[44:45]
    v_pk_add_f32 v[146:147], v[146:147], v[46:47]
    v_accvgpr_read_b32 v68, a196
    v_accvgpr_read_b32 v69, a197
    v_accvgpr_read_b32 v70, a198
    ds_read_b128 v[20:23], v243 offset:1024
    ds_read_b128 v[24:27], v244 offset:1024
    ds_read_b128 v[28:31], v245 offset:1024
    v_accvgpr_read_b32 v71, a199
    v_accvgpr_read_b32 v64, a192
    v_accvgpr_read_b32 v65, a193
    v_accvgpr_read_b32 v66, a194
    v_accvgpr_read_b32 v67, a195
    v_add_f32_dpp v136, v68, v136 row_shr:1 row_mask:0xf bank_mask:0xf bound_ctrl:1
    ds_read_b128 v[72:75], v243 offset:2048
    ds_read_b128 v[76:79], v244 offset:2048
    ds_read_b128 v[80:83], v245 offset:2048
    v_add_f32_dpp v137, v69, v137 row_shr:1 row_mask:0xf bank_mask:0xf bound_ctrl:1
    v_add_f32_dpp v138, v70, v138 row_shr:1 row_mask:0xf bank_mask:0xf bound_ctrl:1
    v_add_f32_dpp v139, v71, v139 row_shr:1 row_mask:0xf bank_mask:0xf bound_ctrl:1
    v_pk_add_f32 v[136:137], v[136:137], v[64:65] neg_lo:[0,1] neg_hi:[0,1]
    v_pk_add_f32 v[138:139], v[138:139], v[66:67] neg_lo:[0,1] neg_hi:[0,1]
    v_accvgpr_read_b32 v52, a68
    ds_read_b128 v[84:87], v243 offset:3072
    ds_read_b128 v[88:91], v244 offset:3072
    ds_read_b128 v[92:95], v245 offset:3072
    v_accvgpr_read_b32 v53, a69
    v_accvgpr_read_b32 v54, a70
    v_accvgpr_read_b32 v55, a71
    v_accvgpr_read_b32 v60, a132
    v_accvgpr_read_b32 v61, a133
    v_accvgpr_read_b32 v62, a134
    v_accvgpr_read_b32 v63, a135
    v_pk_add_f32 v[152:153], v[52:53], v[60:61] neg_lo:[0,1] neg_hi:[0,1]
    v_pk_add_f32 v[154:155], v[54:55], v[62:63] neg_lo:[0,1] neg_hi:[0,1]
    v_pk_add_f32 v[160:161], v[52:53], v[60:61]
    v_pk_add_f32 v[162:163], v[54:55], v[62:63]
    v_pk_add_f32 v[152:153], v[152:153], v[68:69] neg_lo:[0,1] neg_hi:[0,1]
    v_pk_add_f32 v[154:155], v[154:155], v[70:71] neg_lo:[0,1] neg_hi:[0,1]
    v_pk_add_f32 v[152:153], v[152:153], v[64:65]
    v_pk_add_f32 v[154:155], v[154:155], v[66:67]
    v_add_f32_dpp v160, v40, v160 row_shl:1 row_mask:0xf bank_mask:0xf bound_ctrl:1
    v_add_f32_dpp v161, v41, v161 row_shl:1 row_mask:0xf bank_mask:0xf bound_ctrl:1
    v_add_f32_dpp v162, v42, v162 row_shl:1 row_mask:0xf bank_mask:0xf bound_ctrl:1
    v_add_f32_dpp v163, v43, v163 row_shl:1 row_mask:0xf bank_mask:0xf bound_ctrl:1
    v_pk_add_f32 v[160:161], v[160:161], v[44:45] neg_lo:[0,1] neg_hi:[0,1]
    v_pk_add_f32 v[162:163], v[162:163], v[46:47] neg_lo:[0,1] neg_hi:[0,1]
    s_cmp_eq_u32 s4, 0
    s_cbranch_scc1 Lhc0
    s_waitcnt lgkmcnt(6)
    s_nop 0
    v_pk_fma_f32 v[168:169], v[12:13], s[6:7], v[16:17] op_sel:[0,1,0] op_sel_hi:[1,1,1]
    v_pk_fma_f32 v[170:171], v[14:15], s[6:7], v[18:19] op_sel:[0,1,0] op_sel_hi:[1,1,1]
    v_pk_fma_f32 v[12:13], v[12:13], s[6:7], v[8:9] op_sel_hi:[1,0,1]
    v_pk_fma_f32 v[14:15], v[14:15], s[6:7], v[10:11] op_sel_hi:[1,0,1]
    v_pk_fma_f32 v[168:169], v[136:137], s[14:15], v[168:169] op_sel:[0,1,0] op_sel_hi:[1,1,1]
    v_pk_fma_f32 v[170:171], v[138:139], s[14:15], v[170:171] op_sel:[0,1,0] op_sel_hi:[1,1,1]
    v_pk_add_f32 v[136:137], v[136:137], v[12:13]
    v_pk_add_f32 v[138:139], v[138:139], v[14:15]
    v_pk_fma_f32 v[176:177], v[24:25], s[6:7], v[28:29] op_sel:[0,1,0] op_sel_hi:[1,1,1]
    v_pk_fma_f32 v[178:179], v[26:27], s[6:7], v[30:31] op_sel:[0,1,0] op_sel_hi:[1,1,1]
    v_pk_fma_f32 v[24:25], v[24:25], s[6:7], v[20:21] op_sel_hi:[1,0,1]
    v_pk_fma_f32 v[26:27], v[26:27], s[6:7], v[22:23] op_sel_hi:[1,0,1]
    v_pk_fma_f32 v[176:177], v[144:145], s[14:15], v[176:177] op_sel:[0,1,0] op_sel_hi:[1,1,1]
    v_pk_fma_f32 v[178:179], v[146:147], s[14:15], v[178:179] op_sel:[0,1,0] op_sel_hi:[1,1,1]
    v_pk_add_f32 v[144:145], v[144:145], v[24:25]
    v_pk_add_f32 v[146:147], v[146:147], v[26:27]
    s_waitcnt lgkmcnt(0)
    s_nop 0
    v_pk_fma_f32 v[184:185], v[76:77], s[6:7], v[80:81] op_sel:[0,1,0] op_sel_hi:[1,1,1]
    v_pk_fma_f32 v[186:187], v[78:79], s[6:7], v[82:83] op_sel:[0,1,0] op_sel_hi:[1,1,1]
    v_pk_fma_f32 v[76:77], v[76:77], s[6:7], v[72:73] op_sel_hi:[1,0,1]
    v_pk_fma_f32 v[78:79], v[78:79], s[6:7], v[74:75] op_sel_hi:[1,0,1]
    v_pk_fma_f32 v[184:185], v[152:153], s[14:15], v[184:185] op_sel:[0,1,0] op_sel_hi:[1,1,1]
    v_pk_fma_f32 v[186:187], v[154:155], s[14:15], v[186:187] op_sel:[0,1,0] op_sel_hi:[1,1,1]
    v_pk_add_f32 v[152:153], v[152:153], v[76:77]
    v_pk_add_f32 v[154:155], v[154:155], v[78:79]
    v_pk_fma_f32 v[192:193], v[88:89], s[6:7], v[92:93] op_sel:[0,1,0] op_sel_hi:[1,1,1]
    v_pk_fma_f32 v[194:195], v[90:91], s[6:7], v[94:95] op_sel:[0,1,0] op_sel_hi:[1,1,1]
    v_pk_fma_f32 v[88:89], v[88:89], s[6:7], v[84:85] op_sel_hi:[1,0,1]
    v_pk_fma_f32 v[90:91], v[90:91], s[6:7], v[86:87] op_sel_hi:[1,0,1]
    v_pk_fma_f32 v[192:193], v[160:161], s[14:15], v[192:193] op_sel:[0,1,0] op_sel_hi:[1,1,1]
    v_pk_fma_f32 v[194:195], v[162:163], s[14:15], v[194:195] op_sel:[0,1,0] op_sel_hi:[1,1,1]
    v_pk_add_f32 v[160:161], v[160:161], v[88:89]
    v_pk_add_f32 v[162:163], v[162:163], v[90:91]
    s_branch Lhd0
Lhc0:
    s_waitcnt lgkmcnt(6)
    v_pk_fma_f32 v[168:169], v[12:13], s[6:7], v[16:17] op_sel:[0,1,0] op_sel_hi:[1,1,1]
    v_pk_fma_f32 v[170:171], v[14:15], s[6:7], v[18:19] op_sel:[0,1,0] op_sel_hi:[1,1,1]
    v_pk_fma_f32 v[12:13], v[12:13], s[6:7], v[8:9] op_sel_hi:[1,0,1]
    v_pk_fma_f32 v[14:15], v[14:15], s[6:7], v[10:11] op_sel_hi:[1,0,1]
    v_pk_add_f32 v[168:169], v[168:169], v[8:9]
    v_pk_add_f32 v[170:171], v[170:171], v[10:11]
    v_pk_add_f32 v[136:137], v[136:137], v[12:13]
    v_pk_add_f32 v[138:139], v[138:139], v[14:15]
    v_pk_fma_f32 v[176:177], v[24:25], s[6:7], v[28:29] op_sel:[0,1,0] op_sel_hi:[1,1,1]
    v_pk_fma_f32 v[178:179], v[26:27], s[6:7], v[30:31] op_sel:[0,1,0] op_sel_hi:[1,1,1]
    v_pk_fma_f32 v[24:25], v[24:25], s[6:7], v[20:21] op_sel_hi:[1,0,1]
    v_pk_fma_f32 v[26:27], v[26:27], s[6:7], v[22:23] op_sel_hi:[1,0,1]
    v_pk_add_f32 v[176:177], v[176:177], v[20:21]
    v_pk_add_f32 v[178:179], v[178:179], v[22:23]
    v_pk_add_f32 v[144:145], v[144:145], v[24:25]
    v_pk_add_f32 v[146:147], v[146:147], v[26:27]
    s_waitcnt lgkmcnt(0)
    s_nop 0
    v_pk_fma_f32 v[184:185], v[76:77], s[6:7], v[80:81] op_sel:[0,1,0] op_sel_hi:[1,1,1]
    v_pk_fma_f32 v[186:187], v[78:79], s[6:7], v[82:83] op_sel:[0,1,0] op_sel_hi:[1,1,1]
    v_pk_fma_f32 v[76:77], v[76:77], s[6:7], v[72:73] op_sel_hi:[1,0,1]
    v_pk_fma_f32 v[78:79], v[78:79], s[6:7], v[74:75] op_sel_hi:[1,0,1]
    v_pk_add_f32 v[184:185], v[184:185], v[72:73]
    v_pk_add_f32 v[186:187], v[186:187], v[74:75]
    v_pk_add_f32 v[152:153], v[152:153], v[76:77]
    v_pk_add_f32 v[154:155], v[154:155], v[78:79]
    v_pk_fma_f32 v[192:193], v[88:89], s[6:7], v[92:93] op_sel:[0,1,0] op_sel_hi:[1,1,1]
    v_pk_fma_f32 v[194:195], v[90:91], s[6:7], v[94:95] op_sel:[0,1,0] op_sel_hi:[1,1,1]
    v_pk_fma_f32 v[88:89], v[88:89], s[6:7], v[84:85] op_sel_hi:[1,0,1]
    v_pk_fma_f32 v[90:91], v[90:91], s[6:7], v[86:87] op_sel_hi:[1,0,1]
    v_pk_add_f32 v[192:193], v[192:193], v[84:85]
    v_pk_add_f32 v[194:195], v[194:195], v[86:87]
    v_pk_add_f32 v[160:161], v[160:161], v[88:89]
    v_pk_add_f32 v[162:163], v[162:163], v[90:91]
Lhd0:
    s_cmp_lg_u32 s60, 0
    s_cbranch_scc1 Lfinal0
    v_pk_fma_f32 v[136:137], v[136:137], v[232:233], v[104:105] op_sel_hi:[1,0,1]
    v_pk_fma_f32 v[138:139], v[138:139], v[232:233], v[106:107] op_sel_hi:[1,0,1]
    v_pk_fma_f32 v[144:145], v[144:145], v[232:233], v[104:105] op_sel_hi:[1,0,1]
    v_pk_fma_f32 v[146:147], v[146:147], v[232:233], v[106:107] op_sel_hi:[1,0,1]
    v_pk_mul_f32 v[120:121], v[136:137], v[136:137]
    v_pk_mul_f32 v[116:117], v[136:137], 1.0 op_sel_hi:[1,0]
    v_pk_mul_f32 v[122:123], v[138:139], v[138:139]
    v_pk_mul_f32 v[118:119], v[138:139], 1.0 op_sel_hi:[1,0]
    v_pk_add_f32 v[116:117], v[116:117], v[144:145]
    v_pk_fma_f32 v[120:121], v[144:145], v[144:145], v[120:121]
    v_pk_add_f32 v[118:119], v[118:119], v[146:147]
    v_pk_fma_f32 v[122:123], v[146:147], v[146:147], v[122:123]
    v_pk_fma_f32 v[152:153], v[152:153], v[232:233], v[104:105] op_sel_hi:[1,0,1]
    v_pk_fma_f32 v[154:155], v[154:155], v[232:233], v[106:107] op_sel_hi:[1,0,1]
    v_pk_fma_f32 v[160:161], v[160:161], v[232:233], v[104:105] op_sel_hi:[1,0,1]
    v_pk_fma_f32 v[162:163], v[162:163], v[232:233], v[106:107] op_sel_hi:[1,0,1]
    v_pk_add_f32 v[116:117], v[116:117], v[152:153]
    v_pk_fma_f32 v[120:121], v[152:153], v[152:153], v[120:121]
    v_pk_add_f32 v[118:119], v[118:119], v[154:155]
    v_pk_fma_f32 v[122:123], v[154:155], v[154:155], v[122:123]
    v_pk_add_f32 v[116:117], v[116:117], v[160:161]
    v_pk_fma_f32 v[120:121], v[160:161], v[160:161], v[120:121]
    v_pk_add_f32 v[118:119], v[118:119], v[162:163]
    v_pk_fma_f32 v[122:123], v[162:163], v[162:163], v[122:123]
    v_pk_fma_f32 v[168:169], v[168:169], v[232:233], v[104:105] op_sel_hi:[1,0,1]
    v_pk_fma_f32 v[170:171], v[170:171], v[232:233], v[106:107] op_sel_hi:[1,0,1]
    v_pk_fma_f32 v[176:177], v[176:177], v[232:233], v[104:105] op_sel_hi:[1,0,1]
    v_pk_fma_f32 v[178:179], v[178:179], v[232:233], v[106:107] op_sel_hi:[1,0,1]
    v_pk_add_f32 v[116:117], v[116:117], v[168:169]
    v_pk_fma_f32 v[120:121], v[168:169], v[168:169], v[120:121]
    v_pk_add_f32 v[118:119], v[118:119], v[170:171]
    v_pk_fma_f32 v[122:123], v[170:171], v[170:171], v[122:123]
    v_pk_add_f32 v[116:117], v[116:117], v[176:177]
    v_pk_fma_f32 v[120:121], v[176:177], v[176:177], v[120:121]
    v_pk_add_f32 v[118:119], v[118:119], v[178:179]
    v_pk_fma_f32 v[122:123], v[178:179], v[178:179], v[122:123]
    v_pk_fma_f32 v[184:185], v[184:185], v[232:233], v[104:105] op_sel_hi:[1,0,1]
    v_pk_fma_f32 v[186:187], v[186:187], v[232:233], v[106:107] op_sel_hi:[1,0,1]
    v_pk_fma_f32 v[192:193], v[192:193], v[232:233], v[104:105] op_sel_hi:[1,0,1]
    v_pk_fma_f32 v[194:195], v[194:195], v[232:233], v[106:107] op_sel_hi:[1,0,1]
    v_pk_add_f32 v[116:117], v[116:117], v[184:185]
    v_pk_fma_f32 v[120:121], v[184:185], v[184:185], v[120:121]
    v_pk_add_f32 v[118:119], v[118:119], v[186:187]
    v_pk_fma_f32 v[122:123], v[186:187], v[186:187], v[122:123]
    v_pk_add_f32 v[116:117], v[116:117], v[192:193]
    v_pk_fma_f32 v[120:121], v[192:193], v[192:193], v[120:121]
    v_pk_add_f32 v[118:119], v[118:119], v[194:195]
    v_pk_fma_f32 v[122:123], v[194:195], v[194:195], v[122:123]
    s_branch Lhalf
Lfinal0:
    s_mov_b32 s40, s22
    s_mov_b32 s41, s23
    s_mov_b32 s42, 0x800000
    s_waitcnt vmcnt(0)
    v_lshlrev_b32 v40, 16, v200
    v_and_b32 v44, s70, v200
    v_lshlrev_b32 v48, 16, v201
    v_and_b32 v52, s70, v201
    v_lshlrev_b32 v41, 16, v202
    v_and_b32 v45, s70, v202
    v_lshlrev_b32 v49, 16, v203
    v_and_b32 v53, s70, v203
    v_lshlrev_b32 v56, 16, v216
    v_and_b32 v60, s70, v216
    v_lshlrev_b32 v64, 16, v217
    v_and_b32 v68, s70, v217
    v_lshlrev_b32 v57, 16, v218
    v_and_b32 v61, s70, v218
    v_lshlrev_b32 v65, 16, v219
    v_and_b32 v69, s70, v219
    v_pk_fma_f32 v[136:137], v[136:137], v[232:233], v[40:41] op_sel_hi:[1,0,1]
    v_pk_fma_f32 v[144:145], v[144:145], v[232:233], v[44:45] op_sel_hi:[1,0,1]
    v_pk_fma_f32 v[152:153], v[152:153], v[232:233], v[48:49] op_sel_hi:[1,0,1]
    v_pk_fma_f32 v[160:161], v[160:161], v[232:233], v[52:53] op_sel_hi:[1,0,1]
    v_pk_fma_f32 v[168:169], v[168:169], v[232:233], v[56:57] op_sel_hi:[1,0,1]
    v_pk_fma_f32 v[176:177], v[176:177], v[232:233], v[60:61] op_sel_hi:[1,0,1]
    v_pk_fma_f32 v[184:185], v[184:185], v[232:233], v[64:65] op_sel_hi:[1,0,1]
    v_pk_fma_f32 v[192:193], v[192:193], v[232:233], v[68:69] op_sel_hi:[1,0,1]
    v_cvt_pk_bf16_f32 v104, v136, v144
    v_cvt_pk_bf16_f32 v105, v152, v160
    buffer_store_dwordx2 v[104:105], v247, s[40:43], s13 offen sc1
    v_cvt_pk_bf16_f32 v120, v168, v176
    v_cvt_pk_bf16_f32 v121, v184, v192
    buffer_store_dwordx2 v[120:121], v248, s[40:43], s13 offen sc1
    s_add_u32 s13, s13, 8192
    v_cvt_pk_bf16_f32 v106, v137, v145
    v_cvt_pk_bf16_f32 v107, v153, v161
    buffer_store_dwordx2 v[106:107], v247, s[40:43], s13 offen sc1
    v_cvt_pk_bf16_f32 v122, v169, v177
    v_cvt_pk_bf16_f32 v123, v185, v193
    buffer_store_dwordx2 v[122:123], v248, s[40:43], s13 offen sc1
    s_add_u32 s13, s13, 8192
    v_lshlrev_b32 v42, 16, v204
    v_and_b32 v46, s70, v204
    v_lshlrev_b32 v50, 16, v205
    v_and_b32 v54, s70, v205
    v_lshlrev_b32 v43, 16, v206
    v_and_b32 v47, s70, v206
    v_lshlrev_b32 v51, 16, v207
    v_and_b32 v55, s70, v207
    v_lshlrev_b32 v58, 16, v220
    v_and_b32 v62, s70, v220
    v_lshlrev_b32 v66, 16, v221
    v_and_b32 v70, s70, v221
    v_lshlrev_b32 v59, 16, v222
    v_and_b32 v63, s70, v222
    v_lshlrev_b32 v67, 16, v223
    v_and_b32 v71, s70, v223
    v_pk_fma_f32 v[138:139], v[138:139], v[232:233], v[42:43] op_sel_hi:[1,0,1]
    v_pk_fma_f32 v[146:147], v[146:147], v[232:233], v[46:47] op_sel_hi:[1,0,1]
    v_pk_fma_f32 v[154:155], v[154:155], v[232:233], v[50:51] op_sel_hi:[1,0,1]
    v_pk_fma_f32 v[162:163], v[162:163], v[232:233], v[54:55] op_sel_hi:[1,0,1]
    v_pk_fma_f32 v[170:171], v[170:171], v[232:233], v[58:59] op_sel_hi:[1,0,1]
    v_pk_fma_f32 v[178:179], v[178:179], v[232:233], v[62:63] op_sel_hi:[1,0,1]
    v_pk_fma_f32 v[186:187], v[186:187], v[232:233], v[66:67] op_sel_hi:[1,0,1]
    v_pk_fma_f32 v[194:195], v[194:195], v[232:233], v[70:71] op_sel_hi:[1,0,1]
    v_cvt_pk_bf16_f32 v108, v138, v146
    v_cvt_pk_bf16_f32 v109, v154, v162
    buffer_store_dwordx2 v[108:109], v247, s[40:43], s13 offen sc1
    v_cvt_pk_bf16_f32 v124, v170, v178
    v_cvt_pk_bf16_f32 v125, v186, v194
    buffer_store_dwordx2 v[124:125], v248, s[40:43], s13 offen sc1
    s_add_u32 s13, s13, 8192
    v_cvt_pk_bf16_f32 v110, v139, v147
    v_cvt_pk_bf16_f32 v111, v155, v163
    buffer_store_dwordx2 v[110:111], v247, s[40:43], s13 offen sc1
    v_cvt_pk_bf16_f32 v126, v171, v179
    v_cvt_pk_bf16_f32 v127, v187, v195
    buffer_store_dwordx2 v[126:127], v248, s[40:43], s13 offen sc1
    s_add_u32 s13, s13, 8192
Lhalf:
    v_accvgpr_read_b32 v8, a24
    v_accvgpr_read_b32 v9, a25
    v_accvgpr_read_b32 v10, a26
    v_accvgpr_read_b32 v11, a27
    v_accvgpr_read_b32 v12, a28
    v_accvgpr_read_b32 v13, a29
    v_accvgpr_read_b32 v14, a30
    v_accvgpr_read_b32 v15, a31
    v_accvgpr_read_b32 v16, a88
    v_accvgpr_read_b32 v17, a89
    v_accvgpr_read_b32 v18, a90
    v_accvgpr_read_b32 v19, a91
    v_accvgpr_read_b32 v24, a152
    v_accvgpr_read_b32 v25, a153
    v_accvgpr_read_b32 v26, a154
    v_accvgpr_read_b32 v27, a155
    v_pk_add_f32 v[76:77], v[16:17], v[24:25]
    v_pk_add_f32 v[78:79], v[18:19], v[26:27]
    v_pk_add_f32 v[72:73], v[16:17], v[24:25] neg_lo:[0,1] neg_hi:[0,1]
    v_pk_add_f32 v[74:75], v[18:19], v[26:27] neg_lo:[0,1] neg_hi:[0,1]
    v_pk_add_f32 v[76:77], v[76:77], v[8:9] neg_lo:[0,1] neg_hi:[0,1]
    v_pk_add_f32 v[78:79], v[78:79], v[10:11] neg_lo:[0,1] neg_hi:[0,1]
    v_pk_add_f32 v[76:77], v[76:77], v[12:13]
    v_pk_add_f32 v[78:79], v[78:79], v[14:15]
    ds_write_b128 v241, v[76:79] offset:5120
    v_accvgpr_read_b32 v36, a220
    v_accvgpr_read_b32 v37, a221
    v_accvgpr_read_b32 v38, a222
    v_accvgpr_read_b32 v39, a223
    v_accvgpr_read_b32 v32, a216
    v_accvgpr_read_b32 v33, a217
    v_accvgpr_read_b32 v34, a218
    v_accvgpr_read_b32 v35, a219
    v_add_f32_dpp v72, v36, v72 row_shr:1 row_mask:0xf bank_mask:0xf bound_ctrl:1
    v_add_f32_dpp v73, v37, v73 row_shr:1 row_mask:0xf bank_mask:0xf bound_ctrl:1
    v_add_f32_dpp v74, v38, v74 row_shr:1 row_mask:0xf bank_mask:0xf bound_ctrl:1
    v_add_f32_dpp v75, v39, v75 row_shr:1 row_mask:0xf bank_mask:0xf bound_ctrl:1
    v_pk_add_f32 v[72:73], v[72:73], v[32:33] neg_lo:[0,1] neg_hi:[0,1]
    v_pk_add_f32 v[74:75], v[74:75], v[34:35] neg_lo:[0,1] neg_hi:[0,1]
    ds_write_b128 v241, v[72:75] offset:4096
    v_accvgpr_read_b32 v20, a92
    v_accvgpr_read_b32 v21, a93
    v_accvgpr_read_b32 v22, a94
    v_accvgpr_read_b32 v23, a95
    v_accvgpr_read_b32 v28, a156
    v_accvgpr_read_b32 v29, a157
    v_accvgpr_read_b32 v30, a158
    v_accvgpr_read_b32 v31, a159
    v_pk_add_f32 v[80:81], v[20:21], v[28:29] neg_lo:[0,1] neg_hi:[0,1]
    v_pk_add_f32 v[82:83], v[22:23], v[30:31] neg_lo:[0,1] neg_hi:[0,1]
    v_pk_add_f32 v[84:85], v[20:21], v[28:29]
    v_pk_add_f32 v[86:87], v[22:23], v[30:31]
    v_pk_add_f32 v[80:81], v[80:81], v[36:37] neg_lo:[0,1] neg_hi:[0,1]
    v_pk_add_f32 v[82:83], v[82:83], v[38:39] neg_lo:[0,1] neg_hi:[0,1]
    v_pk_add_f32 v[80:81], v[80:81], v[32:33]
    v_pk_add_f32 v[82:83], v[82:83], v[34:35]
    ds_write_b128 v241, v[80:83] offset:6144
    v_add_f32_dpp v84, v8, v84 row_shl:1 row_mask:0xf bank_mask:0xf bound_ctrl:1
    v_add_f32_dpp v85, v9, v85 row_shl:1 row_mask:0xf bank_mask:0xf bound_ctrl:1
    v_add_f32_dpp v86, v10, v86 row_shl:1 row_mask:0xf bank_mask:0xf bound_ctrl:1
    v_add_f32_dpp v87, v11, v87 row_shl:1 row_mask:0xf bank_mask:0xf bound_ctrl:1
    v_pk_add_f32 v[84:85], v[84:85], v[12:13] neg_lo:[0,1] neg_hi:[0,1]
    v_pk_add_f32 v[86:87], v[86:87], v[14:15] neg_lo:[0,1] neg_hi:[0,1]
    v_accvgpr_read_b32 v40, a48
    v_accvgpr_read_b32 v41, a49
    v_accvgpr_read_b32 v42, a50
    v_accvgpr_read_b32 v43, a51
    v_accvgpr_read_b32 v44, a52
    v_accvgpr_read_b32 v45, a53
    v_accvgpr_read_b32 v46, a54
    ds_write_b128 v241, v[84:87] offset:7168
    v_accvgpr_read_b32 v47, a55
    v_accvgpr_read_b32 v48, a112
    v_accvgpr_read_b32 v49, a113
    v_accvgpr_read_b32 v50, a114
    v_accvgpr_read_b32 v51, a115
    v_accvgpr_read_b32 v56, a176
    v_accvgpr_read_b32 v57, a177
    v_accvgpr_read_b32 v58, a178
    v_accvgpr_read_b32 v59, a179
    v_pk_add_f32 v[92:93], v[48:49], v[56:57]
    v_pk_add_f32 v[94:95], v[50:51], v[58:59]
    v_pk_add_f32 v[88:89], v[48:49], v[56:57] neg_lo:[0,1] neg_hi:[0,1]
    v_pk_add_f32 v[90:91], v[50:51], v[58:59] neg_lo:[0,1] neg_hi:[0,1]
    v_pk_add_f32 v[92:93], v[92:93], v[40:41] neg_lo:[0,1] neg_hi:[0,1]
    v_pk_add_f32 v[94:95], v[94:95], v[42:43] neg_lo:[0,1] neg_hi:[0,1]
    v_pk_add_f32 v[92:93], v[92:93], v[44:45]
    v_pk_add_f32 v[94:95], v[94:95], v[46:47]
    ds_write_b128 v240, v[92:95] offset:5120
    v_accvgpr_read_b32 v68, a244
    v_accvgpr_read_b32 v69, a245
    v_accvgpr_read_b32 v70, a246
    v_accvgpr_read_b32 v71, a247
    v_accvgpr_read_b32 v64, a240
    v_accvgpr_read_b32 v65, a241
    v_accvgpr_read_b32 v66, a242
    v_accvgpr_read_b32 v67, a243
    v_add_f32_dpp v88, v68, v88 row_shr:1 row_mask:0xf bank_mask:0xf bound_ctrl:1
    v_add_f32_dpp v89, v69, v89 row_shr:1 row_mask:0xf bank_mask:0xf bound_ctrl:1
    v_add_f32_dpp v90, v70, v90 row_shr:1 row_mask:0xf bank_mask:0xf bound_ctrl:1
    v_add_f32_dpp v91, v71, v91 row_shr:1 row_mask:0xf bank_mask:0xf bound_ctrl:1
    v_pk_add_f32 v[88:89], v[88:89], v[64:65] neg_lo:[0,1] neg_hi:[0,1]
    v_pk_add_f32 v[90:91], v[90:91], v[66:67] neg_lo:[0,1] neg_hi:[0,1]
    ds_write_b128 v240, v[88:91] offset:4096
    v_accvgpr_read_b32 v52, a116
    v_accvgpr_read_b32 v53, a117
    v_accvgpr_read_b32 v54, a118
    v_accvgpr_read_b32 v55, a119
    v_accvgpr_read_b32 v60, a180
    v_accvgpr_read_b32 v61, a181
    v_accvgpr_read_b32 v62, a182
    v_accvgpr_read_b32 v63, a183
    v_pk_add_f32 v[96:97], v[52:53], v[60:61] neg_lo:[0,1] neg_hi:[0,1]
    v_pk_add_f32 v[98:99], v[54:55], v[62:63] neg_lo:[0,1] neg_hi:[0,1]
    v_pk_add_f32 v[100:101], v[52:53], v[60:61]
    v_pk_add_f32 v[102:103], v[54:55], v[62:63]
    v_pk_add_f32 v[96:97], v[96:97], v[68:69] neg_lo:[0,1] neg_hi:[0,1]
    v_pk_add_f32 v[98:99], v[98:99], v[70:71] neg_lo:[0,1] neg_hi:[0,1]
    v_pk_add_f32 v[96:97], v[96:97], v[64:65]
    v_pk_add_f32 v[98:99], v[98:99], v[66:67]
    ds_write_b128 v240, v[96:99] offset:6144
    v_add_f32_dpp v100, v40, v100 row_shl:1 row_mask:0xf bank_mask:0xf bound_ctrl:1
    v_add_f32_dpp v101, v41, v101 row_shl:1 row_mask:0xf bank_mask:0xf bound_ctrl:1
    v_add_f32_dpp v102, v42, v102 row_shl:1 row_mask:0xf bank_mask:0xf bound_ctrl:1
    v_add_f32_dpp v103, v43, v103 row_shl:1 row_mask:0xf bank_mask:0xf bound_ctrl:1
    v_pk_add_f32 v[100:101], v[100:101], v[44:45] neg_lo:[0,1] neg_hi:[0,1]
    v_pk_add_f32 v[102:103], v[102:103], v[46:47] neg_lo:[0,1] neg_hi:[0,1]
    v_accvgpr_read_b32 v8, a56
    v_accvgpr_read_b32 v9, a57
    v_accvgpr_read_b32 v10, a58
    v_accvgpr_read_b32 v11, a59
    v_accvgpr_read_b32 v12, a60
    v_accvgpr_read_b32 v13, a61
    v_accvgpr_read_b32 v14, a62
    ds_write_b128 v240, v[100:103] offset:7168
    v_accvgpr_read_b32 v15, a63
    v_accvgpr_read_b32 v16, a120
    v_accvgpr_read_b32 v17, a121
    v_accvgpr_read_b32 v18, a122
    v_accvgpr_read_b32 v19, a123
    v_accvgpr_read_b32 v24, a184
    v_accvgpr_read_b32 v25, a185
    v_accvgpr_read_b32 v26, a186
    v_accvgpr_read_b32 v27, a187
    s_waitcnt lgkmcnt(4)
    s_nop 0
    v_pk_add_f32 v[76:77], v[16:17], v[24:25]
    v_pk_add_f32 v[78:79], v[18:19], v[26:27]
    v_pk_add_f32 v[72:73], v[16:17], v[24:25] neg_lo:[0,1] neg_hi:[0,1]
    v_pk_add_f32 v[74:75], v[18:19], v[26:27] neg_lo:[0,1] neg_hi:[0,1]
    v_pk_add_f32 v[76:77], v[76:77], v[8:9] neg_lo:[0,1] neg_hi:[0,1]
    v_pk_add_f32 v[78:79], v[78:79], v[10:11] neg_lo:[0,1] neg_hi:[0,1]
    v_pk_add_f32 v[76:77], v[76:77], v[12:13]
    v_pk_add_f32 v[78:79], v[78:79], v[14:15]
    ds_write_b128 v242, v[76:79] offset:5120
    v_accvgpr_read_b32 v36, a252
    v_accvgpr_read_b32 v37, a253
    v_accvgpr_read_b32 v38, a254
    v_accvgpr_read_b32 v39, a255
    v_accvgpr_read_b32 v32, a248
    v_accvgpr_read_b32 v33, a249
    v_accvgpr_read_b32 v34, a250
    v_accvgpr_read_b32 v35, a251
    v_add_f32_dpp v72, v36, v72 row_shr:1 row_mask:0xf bank_mask:0xf bound_ctrl:1
    v_add_f32_dpp v73, v37, v73 row_shr:1 row_mask:0xf bank_mask:0xf bound_ctrl:1
    v_add_f32_dpp v74, v38, v74 row_shr:1 row_mask:0xf bank_mask:0xf bound_ctrl:1
    v_add_f32_dpp v75, v39, v75 row_shr:1 row_mask:0xf bank_mask:0xf bound_ctrl:1
    v_pk_add_f32 v[72:73], v[72:73], v[32:33] neg_lo:[0,1] neg_hi:[0,1]
    v_pk_add_f32 v[74:75], v[74:75], v[34:35] neg_lo:[0,1] neg_hi:[0,1]
    ds_write_b128 v242, v[72:75] offset:4096
    v_accvgpr_read_b32 v20, a124
    v_accvgpr_read_b32 v21, a125
    v_accvgpr_read_b32 v22, a126
    v_accvgpr_read_b32 v23, a127
    v_accvgpr_read_b32 v28, a188
    v_accvgpr_read_b32 v29, a189
    v_accvgpr_read_b32 v30, a190
    v_accvgpr_read_b32 v31, a191
    v_pk_add_f32 v[80:81], v[20:21], v[28:29] neg_lo:[0,1] neg_hi:[0,1]
    v_pk_add_f32 v[82:83], v[22:23], v[30:31] neg_lo:[0,1] neg_hi:[0,1]
    v_pk_add_f32 v[84:85], v[20:21], v[28:29]
    v_pk_add_f32 v[86:87], v[22:23], v[30:31]
    v_pk_add_f32 v[80:81], v[80:81], v[36:37] neg_lo:[0,1] neg_hi:[0,1]
    v_pk_add_f32 v[82:83], v[82:83], v[38:39] neg_lo:[0,1] neg_hi:[0,1]
    v_pk_add_f32 v[80:81], v[80:81], v[32:33]
    v_pk_add_f32 v[82:83], v[82:83], v[34:35]
    ds_write_b128 v242, v[80:83] offset:6144
    v_add_f32_dpp v84, v8, v84 row_shl:1 row_mask:0xf bank_mask:0xf bound_ctrl:1
    v_add_f32_dpp v85, v9, v85 row_shl:1 row_mask:0xf bank_mask:0xf bound_ctrl:1
    v_add_f32_dpp v86, v10, v86 row_shl:1 row_mask:0xf bank_mask:0xf bound_ctrl:1
    v_add_f32_dpp v87, v11, v87 row_shl:1 row_mask:0xf bank_mask:0xf bound_ctrl:1
    v_pk_add_f32 v[84:85], v[84:85], v[12:13] neg_lo:[0,1] neg_hi:[0,1]
    v_pk_add_f32 v[86:87], v[86:87], v[14:15] neg_lo:[0,1] neg_hi:[0,1]
    v_accvgpr_read_b32 v40, a16
    v_accvgpr_read_b32 v41, a17
    v_accvgpr_read_b32 v42, a18
    v_accvgpr_read_b32 v43, a19
    v_accvgpr_read_b32 v44, a20
    v_accvgpr_read_b32 v45, a21
    v_accvgpr_read_b32 v46, a22
    ds_write_b128 v242, v[84:87] offset:7168
    v_accvgpr_read_b32 v47, a23
    v_accvgpr_read_b32 v48, a80
    v_accvgpr_read_b32 v49, a81
    v_accvgpr_read_b32 v50, a82
    v_accvgpr_read_b32 v51, a83
    v_accvgpr_read_b32 v56, a144
    v_accvgpr_read_b32 v57, a145
    v_accvgpr_read_b32 v58, a146
    v_accvgpr_read_b32 v59, a147
    v_pk_add_f32 v[148:149], v[48:49], v[56:57]
    v_pk_add_f32 v[150:151], v[50:51], v[58:59]
    v_pk_add_f32 v[140:141], v[48:49], v[56:57] neg_lo:[0,1] neg_hi:[0,1]
    v_pk_add_f32 v[142:143], v[50:51], v[58:59] neg_lo:[0,1] neg_hi:[0,1]
    v_pk_add_f32 v[148:149], v[148:149], v[40:41] neg_lo:[0,1] neg_hi:[0,1]
    s_waitcnt lgkmcnt(0)
    s_barrier
    ds_read_b128 v[8:11], v243 offset:4096
    ds_read_b128 v[12:15], v244 offset:4096
    ds_read_b128 v[16:19], v245 offset:4096
    v_pk_add_f32 v[150:151], v[150:151], v[42:43] neg_lo:[0,1] neg_hi:[0,1]
    v_pk_add_f32 v[148:149], v[148:149], v[44:45]
    v_pk_add_f32 v[150:151], v[150:151], v[46:47]
    v_accvgpr_read_b32 v68, a212
    v_accvgpr_read_b32 v69, a213
    v_accvgpr_read_b32 v70, a214
    ds_read_b128 v[20:23], v243 offset:5120
    ds_read_b128 v[24:27], v244 offset:5120
    ds_read_b128 v[28:31], v245 offset:5120
    v_accvgpr_read_b32 v71, a215
    v_accvgpr_read_b32 v64, a208
    v_accvgpr_read_b32 v65, a209
    v_accvgpr_read_b32 v66, a210
    v_accvgpr_read_b32 v67, a211
    v_add_f32_dpp v140, v68, v140 row_shr:1 row_mask:0xf bank_mask:0xf bound_ctrl:1
    ds_read_b128 v[72:75], v243 offset:6144
    ds_read_b128 v[76:79], v244 offset:6144
    ds_read_b128 v[80:83], v245 offset:6144
    v_add_f32_dpp v141, v69, v141 row_shr:1 row_mask:0xf bank_mask:0xf bound_ctrl:1
    v_add_f32_dpp v142, v70, v142 row_shr:1 row_mask:0xf bank_mask:0xf bound_ctrl:1
    v_add_f32_dpp v143, v71, v143 row_shr:1 row_mask:0xf bank_mask:0xf bound_ctrl:1
    v_pk_add_f32 v[140:141], v[140:141], v[64:65] neg_lo:[0,1] neg_hi:[0,1]
    v_pk_add_f32 v[142:143], v[142:143], v[66:67] neg_lo:[0,1] neg_hi:[0,1]
    v_accvgpr_read_b32 v52, a84
    ds_read_b128 v[84:87], v243 offset:7168
    ds_read_b128 v[88:91], v244 offset:7168
    ds_read_b128 v[92:95], v245 offset:7168
    v_accvgpr_read_b32 v53, a85
    v_accvgpr_read_b32 v54, a86
    v_accvgpr_read_b32 v55, a87
    v_accvgpr_read_b32 v60, a148
    v_accvgpr_read_b32 v61, a149
    v_accvgpr_read_b32 v62, a150
    v_accvgpr_read_b32 v63, a151
    v_pk_add_f32 v[156:157], v[52:53], v[60:61] neg_lo:[0,1] neg_hi:[0,1]
    v_pk_add_f32 v[158:159], v[54:55], v[62:63] neg_lo:[0,1] neg_hi:[0,1]
    v_pk_add_f32 v[164:165], v[52:53], v[60:61]
    v_pk_add_f32 v[166:167], v[54:55], v[62:63]
    v_pk_add_f32 v[156:157], v[156:157], v[68:69] neg_lo:[0,1] neg_hi:[0,1]
    v_pk_add_f32 v[158:159], v[158:159], v[70:71] neg_lo:[0,1] neg_hi:[0,1]
    v_pk_add_f32 v[156:157], v[156:157], v[64:65]
    v_pk_add_f32 v[158:159], v[158:159], v[66:67]
    v_add_f32_dpp v164, v40, v164 row_shl:1 row_mask:0xf bank_mask:0xf bound_ctrl:1
    v_add_f32_dpp v165, v41, v165 row_shl:1 row_mask:0xf bank_mask:0xf bound_ctrl:1
    v_add_f32_dpp v166, v42, v166 row_shl:1 row_mask:0xf bank_mask:0xf bound_ctrl:1
    v_add_f32_dpp v167, v43, v167 row_shl:1 row_mask:0xf bank_mask:0xf bound_ctrl:1
    v_pk_add_f32 v[164:165], v[164:165], v[44:45] neg_lo:[0,1] neg_hi:[0,1]
    v_pk_add_f32 v[166:167], v[166:167], v[46:47] neg_lo:[0,1] neg_hi:[0,1]
    s_cmp_eq_u32 s4, 0
    s_cbranch_scc1 Lhc1
    s_waitcnt lgkmcnt(6)
    s_nop 0
    v_pk_fma_f32 v[172:173], v[12:13], s[6:7], v[16:17] op_sel:[0,1,0] op_sel_hi:[1,1,1]
    v_pk_fma_f32 v[174:175], v[14:15], s[6:7], v[18:19] op_sel:[0,1,0] op_sel_hi:[1,1,1]
    v_pk_fma_f32 v[12:13], v[12:13], s[6:7], v[8:9] op_sel_hi:[1,0,1]
    v_pk_fma_f32 v[14:15], v[14:15], s[6:7], v[10:11] op_sel_hi:[1,0,1]
    v_pk_fma_f32 v[172:173], v[140:141], s[14:15], v[172:173] op_sel:[0,1,0] op_sel_hi:[1,1,1]
    v_pk_fma_f32 v[174:175], v[142:143], s[14:15], v[174:175] op_sel:[0,1,0] op_sel_hi:[1,1,1]
    v_pk_add_f32 v[140:141], v[140:141], v[12:13]
    v_pk_add_f32 v[142:143], v[142:143], v[14:15]
    v_pk_fma_f32 v[180:181], v[24:25], s[6:7], v[28:29] op_sel:[0,1,0] op_sel_hi:[1,1,1]
    v_pk_fma_f32 v[182:183], v[26:27], s[6:7], v[30:31] op_sel:[0,1,0] op_sel_hi:[1,1,1]
    v_pk_fma_f32 v[24:25], v[24:25], s[6:7], v[20:21] op_sel_hi:[1,0,1]
    v_pk_fma_f32 v[26:27], v[26:27], s[6:7], v[22:23] op_sel_hi:[1,0,1]
    v_pk_fma_f32 v[180:181], v[148:149], s[14:15], v[180:181] op_sel:[0,1,0] op_sel_hi:[1,1,1]
    v_pk_fma_f32 v[182:183], v[150:151], s[14:15], v[182:183] op_sel:[0,1,0] op_sel_hi:[1,1,1]
    v_pk_add_f32 v[148:149], v[148:149], v[24:25]
    v_pk_add_f32 v[150:151], v[150:151], v[26:27]
    s_waitcnt lgkmcnt(0)
    s_nop 0
    v_pk_fma_f32 v[188:189], v[76:77], s[6:7], v[80:81] op_sel:[0,1,0] op_sel_hi:[1,1,1]
    v_pk_fma_f32 v[190:191], v[78:79], s[6:7], v[82:83] op_sel:[0,1,0] op_sel_hi:[1,1,1]
    v_pk_fma_f32 v[76:77], v[76:77], s[6:7], v[72:73] op_sel_hi:[1,0,1]
    v_pk_fma_f32 v[78:79], v[78:79], s[6:7], v[74:75] op_sel_hi:[1,0,1]
    v_pk_fma_f32 v[188:189], v[156:157], s[14:15], v[188:189] op_sel:[0,1,0] op_sel_hi:[1,1,1]
    v_pk_fma_f32 v[190:191], v[158:159], s[14:15], v[190:191] op_sel:[0,1,0] op_sel_hi:[1,1,1]
    v_pk_add_f32 v[156:157], v[156:157], v[76:77]
    v_pk_add_f32 v[158:159], v[158:159], v[78:79]
    v_pk_fma_f32 v[196:197], v[88:89], s[6:7], v[92:93] op_sel:[0,1,0] op_sel_hi:[1,1,1]
    v_pk_fma_f32 v[198:199], v[90:91], s[6:7], v[94:95] op_sel:[0,1,0] op_sel_hi:[1,1,1]
    v_pk_fma_f32 v[88:89], v[88:89], s[6:7], v[84:85] op_sel_hi:[1,0,1]
    v_pk_fma_f32 v[90:91], v[90:91], s[6:7], v[86:87] op_sel_hi:[1,0,1]
    v_pk_fma_f32 v[196:197], v[164:165], s[14:15], v[196:197] op_sel:[0,1,0] op_sel_hi:[1,1,1]
    v_pk_fma_f32 v[198:199], v[166:167], s[14:15], v[198:199] op_sel:[0,1,0] op_sel_hi:[1,1,1]
    v_pk_add_f32 v[164:165], v[164:165], v[88:89]
    v_pk_add_f32 v[166:167], v[166:167], v[90:91]
    s_branch Lhd1
Lhc1:
    s_waitcnt lgkmcnt(6)
    v_pk_fma_f32 v[172:173], v[12:13], s[6:7], v[16:17] op_sel:[0,1,0] op_sel_hi:[1,1,1]
    v_pk_fma_f32 v[174:175], v[14:15], s[6:7], v[18:19] op_sel:[0,1,0] op_sel_hi:[1,1,1]
    v_pk_fma_f32 v[12:13], v[12:13], s[6:7], v[8:9] op_sel_hi:[1,0,1]
    v_pk_fma_f32 v[14:15], v[14:15], s[6:7], v[10:11] op_sel_hi:[1,0,1]
    v_pk_add_f32 v[172:173], v[172:173], v[8:9]
    v_pk_add_f32 v[174:175], v[174:175], v[10:11]
    v_pk_add_f32 v[140:141], v[140:141], v[12:13]
    v_pk_add_f32 v[142:143], v[142:143], v[14:15]
    v_pk_fma_f32 v[180:181], v[24:25], s[6:7], v[28:29] op_sel:[0,1,0] op_sel_hi:[1,1,1]
    v_pk_fma_f32 v[182:183], v[26:27], s[6:7], v[30:31] op_sel:[0,1,0] op_sel_hi:[1,1,1]
    v_pk_fma_f32 v[24:25], v[24:25], s[6:7], v[20:21] op_sel_hi:[1,0,1]
    v_pk_fma_f32 v[26:27], v[26:27], s[6:7], v[22:23] op_sel_hi:[1,0,1]
    v_pk_add_f32 v[180:181], v[180:181], v[20:21]
    v_pk_add_f32 v[182:183], v[182:183], v[22:23]
    v_pk_add_f32 v[148:149], v[148:149], v[24:25]
    v_pk_add_f32 v[150:151], v[150:151], v[26:27]
    s_waitcnt lgkmcnt(0)
    s_nop 0
    v_pk_fma_f32 v[188:189], v[76:77], s[6:7], v[80:81] op_sel:[0,1,0] op_sel_hi:[1,1,1]
    v_pk_fma_f32 v[190:191], v[78:79], s[6:7], v[82:83] op_sel:[0,1,0] op_sel_hi:[1,1,1]
    v_pk_fma_f32 v[76:77], v[76:77], s[6:7], v[72:73] op_sel_hi:[1,0,1]
    v_pk_fma_f32 v[78:79], v[78:79], s[6:7], v[74:75] op_sel_hi:[1,0,1]
    v_pk_add_f32 v[188:189], v[188:189], v[72:73]
    v_pk_add_f32 v[190:191], v[190:191], v[74:75]
    v_pk_add_f32 v[156:157], v[156:157], v[76:77]
    v_pk_add_f32 v[158:159], v[158:159], v[78:79]
    v_pk_fma_f32 v[196:197], v[88:89], s[6:7], v[92:93] op_sel:[0,1,0] op_sel_hi:[1,1,1]
    v_pk_fma_f32 v[198:199], v[90:91], s[6:7], v[94:95] op_sel:[0,1,0] op_sel_hi:[1,1,1]
    v_pk_fma_f32 v[88:89], v[88:89], s[6:7], v[84:85] op_sel_hi:[1,0,1]
    v_pk_fma_f32 v[90:91], v[90:91], s[6:7], v[86:87] op_sel_hi:[1,0,1]
    v_pk_add_f32 v[196:197], v[196:197], v[84:85]
    v_pk_add_f32 v[198:199], v[198:199], v[86:87]
    v_pk_add_f32 v[164:165], v[164:165], v[88:89]
    v_pk_add_f32 v[166:167], v[166:167], v[90:91]
Lhd1:
    s_cmp_lg_u32 s60, 0
    s_cbranch_scc1 Lfinal1
    v_pk_fma_f32 v[140:141], v[140:141], v[232:233], v[108:109] op_sel:[0,1,0] op_sel_hi:[1,1,1]
    v_pk_fma_f32 v[142:143], v[142:143], v[232:233], v[110:111] op_sel:[0,1,0] op_sel_hi:[1,1,1]
    v_pk_fma_f32 v[148:149], v[148:149], v[232:233], v[108:109] op_sel:[0,1,0] op_sel_hi:[1,1,1]
    v_pk_fma_f32 v[150:151], v[150:151], v[232:233], v[110:111] op_sel:[0,1,0] op_sel_hi:[1,1,1]
    v_pk_add_f32 v[116:117], v[116:117], v[140:141]
    v_pk_fma_f32 v[120:121], v[140:141], v[140:141], v[120:121]
    v_pk_add_f32 v[118:119], v[118:119], v[142:143]
    v_pk_fma_f32 v[122:123], v[142:143], v[142:143], v[122:123]
    v_pk_add_f32 v[116:117], v[116:117], v[148:149]
    v_pk_fma_f32 v[120:121], v[148:149], v[148:149], v[120:121]
    v_pk_add_f32 v[118:119], v[118:119], v[150:151]
    v_pk_fma_f32 v[122:123], v[150:151], v[150:151], v[122:123]
    v_pk_fma_f32 v[156:157], v[156:157], v[232:233], v[108:109] op_sel:[0,1,0] op_sel_hi:[1,1,1]
    v_pk_fma_f32 v[158:159], v[158:159], v[232:233], v[110:111] op_sel:[0,1,0] op_sel_hi:[1,1,1]
    v_pk_fma_f32 v[164:165], v[164:165], v[232:233], v[108:109] op_sel:[0,1,0] op_sel_hi:[1,1,1]
    v_pk_fma_f32 v[166:167], v[166:167], v[232:233], v[110:111] op_sel:[0,1,0] op_sel_hi:[1,1,1]
    v_pk_add_f32 v[116:117], v[116:117], v[156:157]
    v_pk_fma_f32 v[120:121], v[156:157], v[156:157], v[120:121]
    v_pk_add_f32 v[118:119], v[118:119], v[158:159]
    v_pk_fma_f32 v[122:123], v[158:159], v[158:159], v[122:123]
    v_pk_add_f32 v[116:117], v[116:117], v[164:165]
    v_pk_fma_f32 v[120:121], v[164:165], v[164:165], v[120:121]
    v_pk_add_f32 v[118:119], v[118:119], v[166:167]
    v_pk_fma_f32 v[122:123], v[166:167], v[166:167], v[122:123]
    v_pk_fma_f32 v[172:173], v[172:173], v[232:233], v[108:109] op_sel:[0,1,0] op_sel_hi:[1,1,1]
    v_pk_fma_f32 v[174:175], v[174:175], v[232:233], v[110:111] op_sel:[0,1,0] op_sel_hi:[1,1,1]
    v_pk_fma_f32 v[180:181], v[180:181], v[232:233], v[108:109] op_sel:[0,1,0] op_sel_hi:[1,1,1]
    v_pk_fma_f32 v[182:183], v[182:183], v[232:233], v[110:111] op_sel:[0,1,0] op_sel_hi:[1,1,1]
    v_pk_add_f32 v[116:117], v[116:117], v[172:173]
    v_pk_fma_f32 v[120:121], v[172:173], v[172:173], v[120:121]
    v_pk_add_f32 v[118:119], v[118:119], v[174:175]
    v_pk_fma_f32 v[122:123], v[174:175], v[174:175], v[122:123]
    v_pk_add_f32 v[116:117], v[116:117], v[180:181]
    v_pk_fma_f32 v[120:121], v[180:181], v[180:181], v[120:121]
    v_pk_add_f32 v[118:119], v[118:119], v[182:183]
    v_pk_fma_f32 v[122:123], v[182:183], v[182:183], v[122:123]
    v_pk_fma_f32 v[188:189], v[188:189], v[232:233], v[108:109] op_sel:[0,1,0] op_sel_hi:[1,1,1]
    v_pk_fma_f32 v[190:191], v[190:191], v[232:233], v[110:111] op_sel:[0,1,0] op_sel_hi:[1,1,1]
    v_pk_fma_f32 v[196:197], v[196:197], v[232:233], v[108:109] op_sel:[0,1,0] op_sel_hi:[1,1,1]
    v_pk_fma_f32 v[198:199], v[198:199], v[232:233], v[110:111] op_sel:[0,1,0] op_sel_hi:[1,1,1]
    v_pk_add_f32 v[116:117], v[116:117], v[188:189]
    v_pk_fma_f32 v[120:121], v[188:189], v[188:189], v[120:121]
    v_pk_add_f32 v[118:119], v[118:119], v[190:191]
    v_pk_fma_f32 v[122:123], v[190:191], v[190:191], v[122:123]
    v_pk_add_f32 v[116:117], v[116:117], v[196:197]
    v_pk_fma_f32 v[120:121], v[196:197], v[196:197], v[120:121]
    v_pk_add_f32 v[118:119], v[118:119], v[198:199]
    v_pk_fma_f32 v[122:123], v[198:199], v[198:199], v[122:123]
    s_mov_b32 s60, 1
    s_mov_b32 s42, 0
    s_add_u32 s66, s66, 0x808000
    s_add_u32 s67, s67, 0x808000
    s_add_u32 s32, s32, 0x808000
    s_addc_u32 s33, s33, 0
    s_branch Lstats
Lfinal1:
    v_lshlrev_b32 v40, 16, v208
    v_and_b32 v44, s70, v208
    v_lshlrev_b32 v48, 16, v209
    v_and_b32 v52, s70, v209
    v_lshlrev_b32 v41, 16, v210
    v_and_b32 v45, s70, v210
    v_lshlrev_b32 v49, 16, v211
    v_and_b32 v53, s70, v211
    v_lshlrev_b32 v56, 16, v224
    v_and_b32 v60, s70, v224
    v_lshlrev_b32 v64, 16, v225
    v_and_b32 v68, s70, v225
    v_lshlrev_b32 v57, 16, v226
    v_and_b32 v61, s70, v226
    v_lshlrev_b32 v65, 16, v227
    v_and_b32 v69, s70, v227
    v_pk_fma_f32 v[140:141], v[140:141], v[232:233], v[40:41] op_sel:[0,1,0] op_sel_hi:[1,1,1]
    v_pk_fma_f32 v[148:149], v[148:149], v[232:233], v[44:45] op_sel:[0,1,0] op_sel_hi:[1,1,1]
    v_pk_fma_f32 v[156:157], v[156:157], v[232:233], v[48:49] op_sel:[0,1,0] op_sel_hi:[1,1,1]
    v_pk_fma_f32 v[164:165], v[164:165], v[232:233], v[52:53] op_sel:[0,1,0] op_sel_hi:[1,1,1]
    v_pk_fma_f32 v[172:173], v[172:173], v[232:233], v[56:57] op_sel:[0,1,0] op_sel_hi:[1,1,1]
    v_pk_fma_f32 v[180:181], v[180:181], v[232:233], v[60:61] op_sel:[0,1,0] op_sel_hi:[1,1,1]
    v_pk_fma_f32 v[188:189], v[188:189], v[232:233], v[64:65] op_sel:[0,1,0] op_sel_hi:[1,1,1]
    v_pk_fma_f32 v[196:197], v[196:197], v[232:233], v[68:69] op_sel:[0,1,0] op_sel_hi:[1,1,1]
    v_cvt_pk_bf16_f32 v112, v140, v148
    v_cvt_pk_bf16_f32 v113, v156, v164
    buffer_store_dwordx2 v[112:113], v247, s[40:43], s13 offen sc1
    v_cvt_pk_bf16_f32 v128, v172, v180
    v_cvt_pk_bf16_f32 v129, v188, v196
    buffer_store_dwordx2 v[128:129], v248, s[40:43], s13 offen sc1
    s_add_u32 s13, s13, 8192
    v_cvt_pk_bf16_f32 v114, v141, v149
    v_cvt_pk_bf16_f32 v115, v157, v165
    buffer_store_dwordx2 v[114:115], v247, s[40:43], s13 offen sc1
    v_cvt_pk_bf16_f32 v130, v173, v181
    v_cvt_pk_bf16_f32 v131, v189, v197
    buffer_store_dwordx2 v[130:131], v248, s[40:43], s13 offen sc1
    s_add_u32 s13, s13, 8192
    v_lshlrev_b32 v42, 16, v212
    v_and_b32 v46, s70, v212
    v_lshlrev_b32 v50, 16, v213
    v_and_b32 v54, s70, v213
    v_lshlrev_b32 v43, 16, v214
    v_and_b32 v47, s70, v214
    v_lshlrev_b32 v51, 16, v215
    v_and_b32 v55, s70, v215
    v_lshlrev_b32 v58, 16, v228
    v_and_b32 v62, s70, v228
    v_lshlrev_b32 v66, 16, v229
    v_and_b32 v70, s70, v229
    v_lshlrev_b32 v59, 16, v230
    v_and_b32 v63, s70, v230
    v_lshlrev_b32 v67, 16, v231
    v_and_b32 v71, s70, v231
    v_pk_fma_f32 v[142:143], v[142:143], v[232:233], v[42:43] op_sel:[0,1,0] op_sel_hi:[1,1,1]
    v_pk_fma_f32 v[150:151], v[150:151], v[232:233], v[46:47] op_sel:[0,1,0] op_sel_hi:[1,1,1]
    v_pk_fma_f32 v[158:159], v[158:159], v[232:233], v[50:51] op_sel:[0,1,0] op_sel_hi:[1,1,1]
    v_pk_fma_f32 v[166:167], v[166:167], v[232:233], v[54:55] op_sel:[0,1,0] op_sel_hi:[1,1,1]
    v_pk_fma_f32 v[174:175], v[174:175], v[232:233], v[58:59] op_sel:[0,1,0] op_sel_hi:[1,1,1]
    v_pk_fma_f32 v[182:183], v[182:183], v[232:233], v[62:63] op_sel:[0,1,0] op_sel_hi:[1,1,1]
    v_pk_fma_f32 v[190:191], v[190:191], v[232:233], v[66:67] op_sel:[0,1,0] op_sel_hi:[1,1,1]
    v_pk_fma_f32 v[198:199], v[198:199], v[232:233], v[70:71] op_sel:[0,1,0] op_sel_hi:[1,1,1]
    v_cvt_pk_bf16_f32 v116, v142, v150
    v_cvt_pk_bf16_f32 v117, v158, v166
    buffer_store_dwordx2 v[116:117], v247, s[40:43], s13 offen sc1
    v_cvt_pk_bf16_f32 v132, v174, v182
    v_cvt_pk_bf16_f32 v133, v190, v198
    buffer_store_dwordx2 v[132:133], v248, s[40:43], s13 offen sc1
    s_add_u32 s13, s13, 8192
    v_cvt_pk_bf16_f32 v118, v143, v151
    v_cvt_pk_bf16_f32 v119, v159, v167
    buffer_store_dwordx2 v[118:119], v247, s[40:43], s13 offen sc1
    v_cvt_pk_bf16_f32 v134, v175, v183
    v_cvt_pk_bf16_f32 v135, v191, v199
    buffer_store_dwordx2 v[134:135], v248, s[40:43], s13 offen sc1
    s_add_u32 s13, s13, 8192
Lexit:
    s_endpgm
Lcode_end:
.section .rodata,"a"
.p2align 6
.amdhsa_kernel standalone__adm_resblock__diffusion_kernel
.amdhsa_next_free_vgpr 512
.amdhsa_next_free_sgpr 102
.amdhsa_accum_offset 256
.amdhsa_group_segment_fixed_size 0
.amdhsa_kernarg_size 96
.amdhsa_user_sgpr_count 2
.amdhsa_user_sgpr_kernarg_segment_ptr 1
.amdhsa_system_sgpr_workgroup_id_x 1
.amdhsa_float_denorm_mode_32 3
.end_amdhsa_kernel
```
